```python
import torch

def _softmax(x, axis=-1):
    return torch.softmax(x, dim=axis)
def _gelu(x):
    return torch.nn.functional.gelu(x, approximate="tanh")
def _silu(x):
    return torch.nn.functional.silu(x)
def _sigmoid(x):
    return torch.sigmoid(x)
def _layernorm(x, axis=-1, eps=1e-5):
    m = x.mean(dim=axis, keepdim=True)
    v = x.var(dim=axis, keepdim=True, unbiased=False)
    return (x - m) / torch.sqrt(v + eps)
def _scatter_add(tgt, idx, src, axis=0):
    return tgt.clone().index_add_(axis, idx, src)
def _segment_sum(src, seg, n):
    out = torch.zeros((n,) + src.shape[1:], dtype=src.dtype)
    return out.index_add_(0, seg, src)
def _pad(x, pw):
    flat = tuple(v for pair in reversed(pw) for v in pair)
    return torch.nn.functional.pad(x, flat)

kernel_name = 'gated_mix__ssm_conv_h3__mixer_s_mlp__prompt'

def setup_inputs():

    _w = (lambda a: (lambda t: t.to(torch.bfloat16) if t.is_floating_point() else t)(torch.as_tensor(a)))
    def _A_setup():
        B, S, D = 1, 2048, 512
        ks = 4
        return {
            "q": _w((lambda *s: torch.randn(*s, dtype=torch.bfloat16) * 0.05)(B, S, D)),
            "k": _w((lambda *s: torch.randn(*s, dtype=torch.bfloat16) * 1.6)(B, S, D)),
            "v": _w((lambda *s: torch.randn(*s, dtype=torch.bfloat16) * 1.6)(B, S, D)),
            "shift_k": _w((lambda *s: torch.randn(*s, dtype=torch.bfloat16) * 1.6)(D, ks) * 0.5),
            "ssm_k": _w((lambda *s: torch.randn(*s, dtype=torch.bfloat16) * 3.2)(D, S) * (1.0 / S ** 0.5)),
            "ssm_D": _w((lambda *s: torch.randn(*s, dtype=torch.bfloat16) * 1.6)(D)),
        }
    _A_in = _A_setup()

    def _B_setup():
        B, S, D, F = 1, 2048, 512, 1792
        return {
            "x":  _w((lambda *s: torch.randn(*s, dtype=torch.bfloat16) * 0.05)(B, S, D)),
            "w1": _w((lambda *s: torch.randn(*s, dtype=torch.bfloat16) * 3.2)(D, D) * (D ** -0.5)),
            "w2": _w((lambda *s: torch.randn(*s, dtype=torch.bfloat16) * 3.2)(D, D) * (D ** -0.5)),
            "w3": _w((lambda *s: torch.randn(*s, dtype=torch.bfloat16) * 3.2)(D, F) * (D ** -0.5)),
            "w4": _w((lambda *s: torch.randn(*s, dtype=torch.bfloat16) * 1.6)(F, D) * (F ** -0.5)),
        }
    _B_in = _B_setup()

    return {
        "A_q": _A_in["q"],
        "A_k": _A_in["k"],
        "A_v": _A_in["v"],
        "A_shift_k": _A_in["shift_k"],
        "A_ssm_k": _A_in["ssm_k"],
        "A_ssm_D": _A_in["ssm_D"],
        "B_x": _B_in["x"],
        "B_w1": _B_in["w1"],
        "B_w2": _B_in["w2"],
        "B_w3": _B_in["w3"],
        "B_w4": _B_in["w4"],
        "gate_w": _w((lambda *s: torch.randn(*s, dtype=torch.bfloat16) * 0.05)(512) * 16.0),
    }

def reference(A_q, A_k, A_v, A_shift_k, A_ssm_k, A_ssm_D, B_x, B_w1, B_w2, B_w3, B_w4, gate_w):
    def _A_ref(q, k, v, shift_k, ssm_k, ssm_D):
        B, S, D = q.shape
        ks = shift_k.shape[-1]
        k_pad = _pad(k, ((0, 0), (ks - 1, 0), (0, 0)))
        k_shift = torch.zeros_like(k)
        for t in range(ks):
            k_shift = k_shift + k_pad[:, t:t + S, :] * shift_k[:, ks - 1 - t][None, None, :]
        kv = k_shift * v
        L = 2 * S
        kv_pad = _pad(kv, ((0, 0), (0, S), (0, 0)))
        kf_pad = _pad(ssm_k, ((0, 0), (0, S)))
        kv_f = (lambda x, axes=(-2,-1): torch.fft.rfft2(x.float(), dim=axes))(kv_pad[:, None, :, :], axes=(1, 2))
        kf_f = (lambda x, axes=(-2,-1): torch.fft.rfft2(x.float(), dim=axes))(kf_pad[:, None, :], axes=(1, 2))
        kf_f = (lambda x, *d: x.permute(*d))(kf_f, 1, 2, 0)
        y_f = kv_f * kf_f[None, :, :, :]
        y = (lambda x, s, axes=(-2,-1): torch.fft.irfft2(x, s=s, dim=axes).to(torch.bfloat16))(y_f, (1, L), axes=(1, 2))[:, 0, :S, :]
        y = y + kv * ssm_D[None, None, :]
        return q * y

    def _B_ref(x, w1, w2, w3, w4):
        B, S, D = x.shape
        h = _gelu(_layernorm(x, axis=-1) @ w1)
        c = D // 4
        g0 = _pad(h[:, :, 0*c:1*c], ((0, 0), (1, 0), (0, 0)))[:, :S, :]
        g1 = _pad(h[:, :, 1*c:2*c], ((0, 0), (0, 1), (0, 0)))[:, 1:, :]
        g2 = _pad(h[:, :, 2*c:3*c], ((0, 0), (2, 0), (0, 0)))[:, :S, :]
        g3 = _pad(h[:, :, 3*c:   ], ((0, 0), (0, 2), (0, 0)))[:, 2:, :]
        hs = torch.concatenate([g0, g1, g2, g3], axis=-1) @ w2
        x1 = x + hs
        h2 = _gelu(_layernorm(x1, axis=-1) @ w3) @ w4
        return x1 + h2

    x = A_q
    g = _sigmoid((x * gate_w).sum(-1, keepdims=True))
    a = _A_ref(x, A_k, A_v, A_shift_k, A_ssm_k, A_ssm_D)
    b = _B_ref(x, B_w1, B_w2, B_w3, B_w4)
    return g * a + (1 - g) * b
```

```asm
; @launch grid=(256,1,1) block=(256,1,1) lds=163840
.amdgcn_target "amdgcn-amd-amdhsa--gfx950"
.text
.globl gated_mix__ssm_conv_h3__mixer_s_mlp__prompt_kernel
.p2align 8
.type gated_mix__ssm_conv_h3__mixer_s_mlp__prompt_kernel,@function
gated_mix__ssm_conv_h3__mixer_s_mlp__prompt_kernel:
    s_cmp_ge_u32 s2, 256
    s_cbranch_scc1 L_end
    s_load_dwordx2 s[4:5], s[0:1], 0
    s_load_dwordx2 s[8:9], s[0:1], 112
    s_load_dwordx2 s[12:13], s[0:1], 56
    s_load_dwordx2 s[16:17], s[0:1], 64
    s_load_dwordx2 s[20:21], s[0:1], 104
    s_load_dwordx2 s[24:25], s[0:1], 8
    s_load_dwordx2 s[28:29], s[0:1], 16
    s_load_dwordx2 s[32:33], s[0:1], 24
    s_load_dwordx2 s[36:37], s[0:1], 40
    s_load_dwordx2 s[40:41], s[0:1], 88
    s_load_dwordx2 s[44:45], s[0:1], 72
    s_load_dwordx2 s[48:49], s[0:1], 80
    s_load_dwordx2 s[52:53], s[0:1], 32
    s_load_dwordx2 s[56:57], s[0:1], 96
    s_getpc_b64 s[64:65]
    s_lshr_b32 s66, s2, 3
    s_mul_i32 s66, s66, 1280
    v_lshl_add_u32 v6, v0, 3, s66
    v_min_u32 v6, L_end-L_pc, v6
L_pc:
    v_mov_b32 v11, s65
    v_add_co_u32 v10, vcc, s64, v6
    s_nop 1
    v_addc_co_u32 v11, vcc, 0, v11, vcc
    global_load_dword v5, v[10:11], off
    v_lshrrev_b32 v6, 6, v0
    v_and_b32 v0, 63, v0
    v_readfirstlane_b32 s3, v6
    s_and_b32 s63, s2, 7
    s_lshr_b32 s64, s2, 3
    s_and_b32 s60, s64, 7
    s_lshr_b32 s62, s64, 3
    s_lshl_b32 s61, s63, 2
    s_add_u32 s61, s61, s62
    s_mov_b32 s6, 2097152
    s_mov_b32 s7, 0x00020000
    s_mov_b32 s10, 268435456
    s_mov_b32 s11, 0x00020000
    s_mov_b32 s14, 524288
    s_mov_b32 s15, 0x00020000
    s_mov_b32 s18, 524288
    s_mov_b32 s19, 0x00020000
    v_and_b32 v9, 15, v0
    v_lshrrev_b32 v10, 4, v0
    v_lshrrev_b32 v11, 3, v0
    v_lshlrev_b32 v11, 10, v11
    v_and_b32 v12, 7, v0
    s_lshl_b32 s73, s3, 14
    s_lshl_b32 s74, s60, 7
    s_lshl_b32 s75, s61, 16
    s_add_u32 s75, s75, s74
    s_add_u32 s76, s73, s75
    s_lshl_b32 s78, s3, 11
    s_add_u32 s77, s76, 7168
    s_lshr_b32 s64, s60, 2
    s_add_u32 s64, s64, 1
    s_sub_u32 s65, 0, s64
    s_bitcmp1_b32 s60, 1
    s_cselect_b32 s64, s64, s65
    s_lshl_b32 s64, s64, 10
    s_sub_u32 s65, s76, s74
    s_add_u32 s64, s64, s65
    v_xor_b32 v6, v12, v10
    v_lshl_add_u32 v14, v6, 4, v11
    v_xor_b32 v15, 64, v14
    v_add_u32 v15, 7168, v15
    v_add_u32 v16, s64, v14
    v_add_u32 v17, s64, v15
    s_waitcnt lgkmcnt(0)
    s_add_u32 m0, s73, 0
    s_xor_b32 s81, s74, 0
    buffer_load_dwordx4 v16, s[4:7], s81 offen offset:0 lds
    buffer_load_dwordx4 v17, s[4:7], s81 offen offset:1024 lds
    s_lshr_b32 s81, s2, 3
    s_lshl_b32 s81, s81, 2
    s_add_u32 s81, s81, s3
    s_mul_i32 s81, s81, 4096
    v_min_u32 v2, 3, v0
    v_lshlrev_b32 v2, 10, v2
    buffer_load_dword v5, v2, s[12:15], s81 offen offset:384
    buffer_load_dword v5, v2, s[16:19], s81 offen offset:384
    s_lshl_b32 s81, s2, 2
    s_add_u32 s81, s81, s3
    s_mul_i32 s81, s81, 512
    v_min_u32 v2, 3, v0
    v_lshlrev_b32_e64 v2, 7, v2
    buffer_load_dword v5, v2, s[12:15], s81 offen
    buffer_load_dword v5, v2, s[16:19], s81 offen
    s_add_u32 m0, s73, 2048
    s_xor_b32 s81, s74, 128
    buffer_load_dwordx4 v16, s[4:7], s81 offen offset:0 lds
    buffer_load_dwordx4 v17, s[4:7], s81 offen offset:1024 lds
    v_and_b32 v13, 31, v0
    v_lshlrev_b32 v13, 2, v13
    s_lshl_b32 s82, s61, 12
    v_lshlrev_b32 v3, 4, v0
    v_mov_b32 v160, 0
    v_mov_b32 v161, 0
    v_mov_b32 v162, 0
    v_mov_b32 v163, 0
    v_lshlrev_b32 v6, 4, v12
    s_lshl_b32 s84, s61, 7
    s_add_u32 s84, s84, 131072
    s_lshl_b32 s64, s60, 2
    s_add_u32 s64, s64, s3
    s_lshl_b32 s83, s64, 7
    s_add_u32 s83, s83, s82
    s_lshl_b32 s85, s64, 2
    s_add_u32 s85, s85, s84
    s_lshl_b32 s65, s61, 2
    s_cmp_eq_u32 s64, 0
    s_cselect_b32 s86, s65, 1073741824
    s_cselect_b32 s66, s84, 1073741824
    s_lshl_b32 s65, s3, 10
    s_add_u32 s65, s65, s82
    s_cmp_eq_u32 s60, 0
    s_cselect_b32 s67, s65, 1073741824
    buffer_store_dwordx4 v[160:163], v3, s[8:11], s67 offen sc1
    buffer_store_dwordx4 v[160:163], v6, s[8:11], s66 offen sc1
    s_mov_b32 s22, 256
    s_mov_b32 s23, 0x00020000
    s_mov_b32 s26, 2097152
    s_mov_b32 s27, 0x00020000
    s_mov_b32 s30, 2097152
    s_mov_b32 s31, 0x00020000
    s_mov_b32 s34, 4096
    s_mov_b32 s35, 0x00020000
    s_mov_b32 s38, 1024
    s_mov_b32 s39, 0x00020000
    s_mov_b32 s42, 1024
    s_mov_b32 s43, 0x00020000
    s_mov_b32 s46, 1835008
    s_mov_b32 s47, 0x00020000
    s_mov_b32 s50, 1835008
    s_mov_b32 s51, 0x00020000
    s_mov_b32 s54, 2097152
    s_mov_b32 s55, 0x00020000
    s_mov_b32 s58, 2097152
    s_mov_b32 s59, 0x00020000
    v_and_b32 v6, 1, v10
    v_lshlrev_b32 v6, 1, v6
    v_xor_b32 v6, v6, v12
    v_lshl_add_u32 v152, v6, 4, v11
    v_xor_b32 v6, 64, v152
    v_add_u32 v153, 7168, v6
    v_add_u32 v154, 14336, v152
    v_add_u32 v155, 21504, v6
    s_add_u32 m0, s73, 4096
    s_xor_b32 s81, s74, 256
    buffer_load_dwordx4 v16, s[4:7], s81 offen offset:0 lds
    s_and_b32 s64, s62, 1
    s_lshl_b32 s64, s64, 2
    s_add_u32 s64, s64, s3
    s_lshl_b32 s79, s64, 12
    s_lshl_b32 s65, s60, 1
    s_xor_b32 s64, s64, s65
    s_lshl_b32 s80, s64, 15
    s_add_u32 s80, s80, s74
    v_lshlrev_b32 v6, 1, v10
    v_xor_b32 v6, v6, v12
    v_lshl_add_u32 v18, v6, 4, v11
    v_lshrrev_b32 v7, 5, v0
    v_lshlrev_b32 v7, 1, v7
    v_xor_b32 v7, v7, v12
    v_lshl_add_u32 v20, v7, 4, v11
    v_xor_b32 v21, 64, v20
    buffer_load_dwordx4 v17, s[4:7], s81 offen offset:1024 lds
    s_sub_u32 s64, s75, 8192
    s_add_u32 s65, s78, 148992
    s_cmp_eq_u32 s3, 0
    s_cselect_b32 s64, s64, 1073741824
    s_cselect_b32 s87, 131072, s65
    v_add_u32 v19, s64, v18
    v_lshlrev_b32 v22, 3, v9
    s_lshl_b32 s66, s60, 9
    s_lshl_b32 s67, s3, 7
    s_add_u32 s88, s66, s67
    s_mov_b32 s68, 0x3f803f80
    s_mov_b32 s69, 0x00003f80
    s_mov_b32 s70, 0x3f800000
    s_add_u32 m0, s73, 6144
    s_xor_b32 s81, s74, 384
    buffer_load_dwordx4 v16, s[4:7], s81 offen offset:0 lds
    s_mov_b32 s71, 0xffff0000
    s_mov_b32 s72, 0x40000
    v_lshlrev_b32 v4, 2, v0
    v_bfe_u32 v11, v0, 2, 2
    v_and_b32 v23, 3, v0
    v_lshlrev_b32 v23, 3, v23
    v_sub_u32 v6, v10, v11
    v_add_u32 v6, 8, v6
    v_bfe_u32 v7, v6, 1, 2
    v_xor_b32 v7, s3, v7
    v_lshl_add_u32 v7, v7, 5, v23
    v_lshl_add_u32 v7, v6, 7, v7
    v_add_u32 v24, 131072, v7
    buffer_load_dwordx4 v17, s[4:7], s81 offen offset:1024 lds
    v_sub_u32 v6, v10, v11
    v_add_u32 v6, 12, v6
    v_bfe_u32 v7, v6, 1, 2
    v_xor_b32_e64 v7, s3, v7
    v_lshl_add_u32 v7, v7, 5, v23
    v_lshl_add_u32 v7, v6, 7, v7
    v_add_u32 v25, 131072, v7
    v_lshl_add_u32 v6, v11, 2, v10
    v_xor_b32_e64 v7, s3, v11
    v_lshl_add_u32 v7, v7, 5, v23
    v_lshl_add_u32 v7, v6, 7, v7
    v_add_u32 v26, 140288, v7
    s_add_u32 s89, s78, 148992
    s_lshr_b32 s64, s61, 1
    v_add_u32 v7, s64, v10
    v_and_b32 v7, 3, v7
    v_lshlrev_b32 v7, 1, v7
    v_and_b32 v6, 7, v9
    v_xor_b32 v6, v6, v7
    v_lshlrev_b32 v6, 4, v6
    v_lshl_add_u32 v6, v9, 7, v6
    v_add_u32 v28, s89, v6
    v_lshrrev_b32 v6, 3, v0
    v_xor_b32 v7, v6, v12
    v_lshlrev_b32 v7, 4, v7
    v_lshl_add_u32 v7, v6, 7, v7
    v_add_u32 v29, s89, v7
    v_lshlrev_b32 v8, 4, v12
    v_lshl_add_u32 v27, v6, 12, v8
    v_lshrrev_b32 v6, 1, v9
    v_xor_b32 v6, v6, v10
    v_lshlrev_b32 v6, 4, v6
    v_lshl_add_u32 v6, v9, 7, v6
    v_add_u32 v30, s73, v6
    v_xor_b32 v31, 64, v30
    v_lshl_add_u32 v6, v10, 3, v11
    v_lshl_add_u32 v6, v6, 7, v23
    v_lshrrev_b32 v7, 1, v11
    v_and_b32 v8, 1, v10
    v_lshl_or_b32 v7, v8, 1, v7
    v_xor_b32 v7, s3, v7
    v_lshl_add_u32 v6, v7, 5, v6
    v_add_u32 v144, 65536, v6
    v_xor_b32 v145, 32, v144
    v_xor_b32 v146, 64, v144
    v_xor_b32 v147, 96, v144
    s_lshr_b32 s66, s3, 1
    s_and_b32 s67, s3, 1
    s_lshl_b32 s90, s60, 5
    s_add_u32 s90, s90, s61
    s_lshl_b32 s90, s90, 1
    s_add_u32 s90, s90, s66
    s_sub_u32 s91, s76, s74
    s_lshl_b32 s64, s60, 11
    s_add_u32 s91, s91, s64
    s_add_u32 s91, s91, 1048576
    s_lshl_b32 s64, s66, 10
    s_add_u32 s92, s91, s64
    s_xor_b32 s93, s92, 1024
    s_lshr_b32 s64, s60, 1
    s_mul_i32 s94, s64, 7
    s_and_b32 s65, s60, 1
    s_lshl_b32 s66, s65, 2
    s_add_u32 s66, s66, s3
    s_add_u32 s94, s94, s66
    s_cmp_eq_u32 s66, 7
    s_cselect_b32 s97, 1073741824, 0
    s_lshl_b32 s95, s94, 7
    s_add_u32 s95, s95, s97
    s_add_u32 s98, s73, 65536
    v_lshrrev_b32 v6, 3, v0
    v_and_b32 v7, 1, v10
    v_lshlrev_b32 v7, 2, v7
    v_xor_b32 v8, v7, v12
    v_lshlrev_b32 v8, 4, v8
    v_mul_u32_u24 v32, 3584, v6
    v_add_u32 v32, v32, v8
    v_add_u32 v33, 27648, v32
    v_add_u32 v34, 55296, v32
    v_add_u32 v35, 82944, v32
    v_lshrrev_b32 v6, 5, v0
    v_lshl_add_u32 v6, v6, 2, v11
    v_lshl_add_u32 v6, v6, 7, v23
    v_and_b32 v7, 1, v10
    v_lshl_add_u32 v6, v7, 5, v6
    v_lshrrev_b32 v7, 1, v11
    v_lshl_add_u32 v6, v7, 6, v6
    v_add_u32 v36, s98, v6
    v_xor_b32 v37, 64, v36
    v_mov_b32 v120, 0
    v_mov_b32 v176, s68
    v_mov_b32 v121, 0
    v_mov_b32 v177, s68
    v_mov_b32 v122, 0
    v_mov_b32 v178, s68
    v_mov_b32 v123, 0
    v_mov_b32 v179, s68
    s_lshl_b32 s64, s3, 6
    s_add_u32 s64, s64, 157184
    v_lshl_add_u32 v38, v10, 4, s64
    s_waitcnt vmcnt(12)
    s_add_u32 m0, s73, 8192
    s_xor_b32 s81, s74, 512
    buffer_load_dwordx4 v16, s[4:7], s81 offen offset:0 lds
    ds_read_b128 v[48:51], v30 offset:0
    ds_read_b128 v[52:55], v31 offset:0
    s_waitcnt vmcnt(7)
    ds_read_b128 v[56:59], v30 offset:2048
    ds_read_b128 v[60:63], v31 offset:2048
    s_waitcnt lgkmcnt(2)
    buffer_load_dwordx4 v17, s[4:7], s81 offen offset:1024 lds
    v_dot2c_f32_bf16 v120, s68, v48
    v_dot2c_f32_bf16 v122, v48, v48
    v_dot2c_f32_bf16 v121, s68, v49
    v_dot2c_f32_bf16 v123, v49, v49
    v_dot2c_f32_bf16 v120, s68, v50
    v_dot2c_f32_bf16 v122, v50, v50
    v_dot2c_f32_bf16 v121, s68, v51
    v_dot2c_f32_bf16 v123, v51, v51
    v_dot2c_f32_bf16 v120, s68, v52
    s_add_u32 m0, s73, 10240
    s_xor_b32 s81, s74, 640
    buffer_load_dwordx4 v16, s[4:7], s81 offen offset:0 lds
    v_dot2c_f32_bf16 v122, v52, v52
    v_dot2c_f32_bf16 v121, s68, v53
    v_dot2c_f32_bf16 v123, v53, v53
    v_dot2c_f32_bf16 v120, s68, v54
    v_dot2c_f32_bf16 v122, v54, v54
    v_dot2c_f32_bf16 v121, s68, v55
    v_dot2c_f32_bf16 v123, v55, v55
    s_waitcnt vmcnt(5)
    ds_read_b128 v[64:67], v30 offset:4096
    ds_read_b128 v[68:71], v31 offset:4096
    s_waitcnt lgkmcnt(2)
    v_dot2c_f32_bf16 v120, s68, v56
    v_dot2c_f32_bf16 v122, v56, v56
    buffer_load_dwordx4 v17, s[4:7], s81 offen offset:1024 lds
    v_dot2c_f32_bf16 v121, s68, v57
    v_dot2c_f32_bf16 v123, v57, v57
    v_dot2c_f32_bf16 v120, s68, v58
    v_dot2c_f32_bf16 v122, v58, v58
    v_dot2c_f32_bf16 v121, s68, v59
    v_dot2c_f32_bf16 v123, v59, v59
    v_dot2c_f32_bf16 v120, s68, v60
    v_dot2c_f32_bf16 v122, v60, v60
    v_dot2c_f32_bf16 v121, s68, v61
    v_dot2c_f32_bf16 v123, v61, v61
    v_dot2c_f32_bf16 v120, s68, v62
    v_dot2c_f32_bf16 v122, v62, v62
    v_dot2c_f32_bf16 v121, s68, v63
    v_dot2c_f32_bf16 v123, v63, v63
    s_waitcnt vmcnt(4)
    ds_read_b128 v[72:75], v30 offset:6144
    s_add_u32 m0, s73, 12288
    s_xor_b32 s81, s74, 768
    buffer_load_dwordx4 v16, s[4:7], s81 offen offset:0 lds
    ds_read_b128 v[76:79], v31 offset:6144
    s_waitcnt lgkmcnt(2)
    v_dot2c_f32_bf16 v120, s68, v64
    v_dot2c_f32_bf16 v122, v64, v64
    v_dot2c_f32_bf16 v121, s68, v65
    v_dot2c_f32_bf16 v123, v65, v65
    v_dot2c_f32_bf16 v120, s68, v66
    v_dot2c_f32_bf16 v122, v66, v66
    v_dot2c_f32_bf16 v121, s68, v67
    v_dot2c_f32_bf16 v123, v67, v67
    v_dot2c_f32_bf16 v120, s68, v68
    v_dot2c_f32_bf16 v122, v68, v68
    v_dot2c_f32_bf16 v121, s68, v69
    buffer_load_dwordx4 v17, s[4:7], s81 offen offset:1024 lds
    v_dot2c_f32_bf16 v123, v69, v69
    v_dot2c_f32_bf16 v120, s68, v70
    v_dot2c_f32_bf16 v122, v70, v70
    v_dot2c_f32_bf16 v121, s68, v71
    v_dot2c_f32_bf16 v123, v71, v71
    s_waitcnt vmcnt(4)
    s_add_u32 m0, s73, 14336
    s_xor_b32 s81, s74, 896
    buffer_load_dwordx4 v16, s[4:7], s81 offen offset:0 lds
    ds_read_b128 v[80:83], v30 offset:8192
    ds_read_b128 v[84:87], v31 offset:8192
    s_waitcnt lgkmcnt(2)
    v_dot2c_f32_bf16 v120, s68, v72
    v_dot2c_f32_bf16 v122, v72, v72
    v_dot2c_f32_bf16 v121, s68, v73
    v_dot2c_f32_bf16 v123, v73, v73
    v_dot2c_f32_bf16 v120, s68, v74
    v_dot2c_f32_bf16 v122, v74, v74
    buffer_load_dwordx4 v17, s[4:7], s81 offen offset:1024 lds
    v_dot2c_f32_bf16 v121, s68, v75
    v_dot2c_f32_bf16 v123, v75, v75
    v_dot2c_f32_bf16 v120, s68, v76
    v_dot2c_f32_bf16 v122, v76, v76
    v_dot2c_f32_bf16 v121, s68, v77
    v_dot2c_f32_bf16 v123, v77, v77
    v_dot2c_f32_bf16 v120, s68, v78
    v_dot2c_f32_bf16 v122, v78, v78
    v_dot2c_f32_bf16 v121, s68, v79
    v_dot2c_f32_bf16 v123, v79, v79
    s_waitcnt vmcnt(4)
    s_xor_b32 m0, s79, 65536
    s_xor_b32 s81, s80, 0
    buffer_load_dwordx4 v152, s[12:15], s81 offen offset:0 lds
    ds_read_b128 v[88:91], v30 offset:10240
    ds_read_b128 v[92:95], v31 offset:10240
    s_waitcnt lgkmcnt(2)
    v_dot2c_f32_bf16 v120, s68, v80
    v_dot2c_f32_bf16 v122, v80, v80
    v_dot2c_f32_bf16 v121, s68, v81
    v_dot2c_f32_bf16 v123, v81, v81
    v_dot2c_f32_bf16 v120, s68, v82
    v_dot2c_f32_bf16 v122, v82, v82
    buffer_load_dwordx4 v153, s[12:15], s81 offen offset:1024 lds
    v_dot2c_f32_bf16 v121, s68, v83
    v_dot2c_f32_bf16 v123, v83, v83
    v_dot2c_f32_bf16 v120, s68, v84
    v_dot2c_f32_bf16 v122, v84, v84
    v_dot2c_f32_bf16 v121, s68, v85
    v_dot2c_f32_bf16 v123, v85, v85
    v_dot2c_f32_bf16 v120, s68, v86
    v_dot2c_f32_bf16 v122, v86, v86
    v_dot2c_f32_bf16 v121, s68, v87
    v_dot2c_f32_bf16 v123, v87, v87
    s_waitcnt vmcnt(4)
    buffer_load_dwordx4 v154, s[12:15], s81 offen offset:2048 lds
    ds_read_b128 v[96:99], v30 offset:12288
    ds_read_b128 v[100:103], v31 offset:12288
    s_waitcnt lgkmcnt(2)
    v_dot2c_f32_bf16 v120, s68, v88
    v_dot2c_f32_bf16 v122, v88, v88
    v_dot2c_f32_bf16 v121, s68, v89
    v_dot2c_f32_bf16 v123, v89, v89
    v_dot2c_f32_bf16 v120, s68, v90
    v_dot2c_f32_bf16 v122, v90, v90
    buffer_load_dwordx4 v155, s[12:15], s81 offen offset:3072 lds
    v_dot2c_f32_bf16 v121, s68, v91
    v_dot2c_f32_bf16 v123, v91, v91
    v_dot2c_f32_bf16 v120, s68, v92
    v_dot2c_f32_bf16 v122, v92, v92
    v_dot2c_f32_bf16 v121, s68, v93
    v_dot2c_f32_bf16 v123, v93, v93
    v_dot2c_f32_bf16 v120, s68, v94
    v_dot2c_f32_bf16 v122, v94, v94
    v_dot2c_f32_bf16 v121, s68, v95
    v_dot2c_f32_bf16 v123, v95, v95
    s_waitcnt vmcnt(4)
    s_xor_b32 m0, s79, 81920
    s_xor_b32 s81, s80, 131072
    buffer_load_dwordx4 v152, s[12:15], s81 offen offset:0 lds
    ds_read_b128 v[104:107], v30 offset:14336
    ds_read_b128 v[108:111], v31 offset:14336
    s_waitcnt lgkmcnt(2)
    v_dot2c_f32_bf16 v120, s68, v96
    v_dot2c_f32_bf16 v122, v96, v96
    v_dot2c_f32_bf16 v121, s68, v97
    v_dot2c_f32_bf16 v123, v97, v97
    v_dot2c_f32_bf16 v120, s68, v98
    v_dot2c_f32_bf16 v122, v98, v98
    buffer_load_dwordx4 v153, s[12:15], s81 offen offset:1024 lds
    v_dot2c_f32_bf16 v121, s68, v99
    v_dot2c_f32_bf16 v123, v99, v99
    v_dot2c_f32_bf16 v120, s68, v100
    v_dot2c_f32_bf16 v122, v100, v100
    v_dot2c_f32_bf16 v121, s68, v101
    v_dot2c_f32_bf16 v123, v101, v101
    v_dot2c_f32_bf16 v120, s68, v102
    v_dot2c_f32_bf16 v122, v102, v102
    v_dot2c_f32_bf16 v121, s68, v103
    v_dot2c_f32_bf16 v123, v103, v103
    s_waitcnt lgkmcnt(0)
    buffer_load_dwordx4 v154, s[12:15], s81 offen offset:2048 lds
    v_dot2c_f32_bf16 v120, s68, v104
    v_dot2c_f32_bf16 v122, v104, v104
    v_dot2c_f32_bf16 v121, s68, v105
    v_dot2c_f32_bf16 v123, v105, v105
    v_dot2c_f32_bf16 v120, s68, v106
    v_dot2c_f32_bf16 v122, v106, v106
    v_dot2c_f32_bf16 v121, s68, v107
    v_dot2c_f32_bf16 v123, v107, v107
    v_dot2c_f32_bf16 v120, s68, v108
    v_dot2c_f32_bf16 v122, v108, v108
    v_dot2c_f32_bf16 v121, s68, v109
    v_dot2c_f32_bf16 v123, v109, v109
    v_dot2c_f32_bf16 v120, s68, v110
    v_dot2c_f32_bf16 v122, v110, v110
    v_dot2c_f32_bf16 v121, s68, v111
    v_dot2c_f32_bf16 v123, v111, v111
    buffer_load_dwordx4 v155, s[12:15], s81 offen offset:3072 lds
    s_nop 0
    v_add_f32 v120, v120, v121
    v_add_f32 v122, v122, v123
    v_mov_b32 v121, v120
    v_mov_b32 v123, v122
    s_nop 0
    v_permlane32_swap_b32 v120, v121
    v_permlane32_swap_b32 v122, v123
    v_add_f32 v120, v120, v121
    v_add_f32 v122, v122, v123
    v_mov_b32 v121, v120
    v_mov_b32 v123, v122
    s_nop 0
    v_permlane16_swap_b32 v120, v121
    v_permlane16_swap_b32 v122, v123
    v_add_f32 v120, v120, v121
    v_add_f32 v122, v122, v123
    v_mul_f32 v121, 0xbb000000, v120
    s_xor_b32 m0, s79, 98304
    s_xor_b32 s81, s80, 262144
    buffer_load_dwordx4 v152, s[12:15], s81 offen offset:0 lds
    v_mul_f32 v122, 0x3b000000, v122
    v_fma_f32 v122, -v121, v121, v122
    v_max_f32 v122, 0, v122
    v_cvt_pk_bf16_f32 v122, v122, v122
    v_and_b32 v122, s71, v122
    v_add_f32 v122, 0x3727c5ac, v122
    v_cvt_pk_bf16_f32 v122, v122, v122
    v_and_b32 v122, s71, v122
    v_sqrt_f32 v126, v122
    v_cvt_pk_bf16_f32 v121, v121, v121
    v_and_b32 v121, s71, v121
    v_cvt_pk_bf16_f32 v126, v126, v126
    v_and_b32 v126, s71, v126
    buffer_load_dwordx4 v153, s[12:15], s81 offen offset:1024 lds
    v_rcp_f32 v122, v126
    s_nop 0
    v_mul_f32 v125, 0xc0135761, v122
    v_mul_f32 v124, v122, v122
    v_mul_f32 v124, v124, v122
    v_mul_f32 v124, 0xbdd2d3e8, v124
    buffer_load_dwordx4 v154, s[12:15], s81 offen offset:2048 lds
    buffer_load_dwordx4 v155, s[12:15], s81 offen offset:3072 lds
    s_xor_b32 m0, s79, 114688
    s_xor_b32 s81, s80, 393216
    buffer_load_dwordx4 v152, s[12:15], s81 offen offset:0 lds
    buffer_load_dwordx4 v153, s[12:15], s81 offen offset:1024 lds
    buffer_load_dwordx4 v154, s[12:15], s81 offen offset:2048 lds
    buffer_load_dwordx4 v155, s[12:15], s81 offen offset:3072 lds
    s_lshl_b32 s81, s2, 2
    s_add_u32 s81, s81, s3
    s_mul_i32 s81, s81, 1792
    v_min_u32 v2, 13, v0
    v_lshlrev_b32 v2, 7, v2
    buffer_load_dword v5, v2, s[44:47], s81 offen
    v_add_u32_e64 v152, 0, v18
    v_add_u32 v153, 7168, v18
    v_add_u32 v154, 14336, v18
    v_add_u32 v155, 21504, v18
    s_lshl_b32 s64, s3, 2
    s_xor_b32 s64, s64, s62
    s_lshl_b32 s79, s64, 12
    s_lshl_b32 s65, s60, 1
    s_xor_b32 s64, s64, s65
    s_lshl_b32 s80, s64, 15
    s_add_u32 s80, s80, s74
    s_lshl_b32 s67, s90, 1
    v_lshlrev_b32 v8, 3, v10
    v_mov_b32 v16, 0
    s_waitcnt vmcnt(9)
    s_barrier
    ds_read_b64_tr_b16 v[192:193], v144 offset:0
    ds_read_b64_tr_b16 v[194:195], v144 offset:512
    ds_read_b64_tr_b16 v[196:197], v145 offset:0
    ds_read_b64_tr_b16 v[198:199], v145 offset:512
    ds_read_b64_tr_b16 v[200:201], v146 offset:0
    ds_read_b64_tr_b16 v[202:203], v146 offset:512
    ds_read_b64_tr_b16 v[204:205], v147 offset:0
    ds_read_b64_tr_b16 v[206:207], v147 offset:512
    ds_read_b64_tr_b16 v[208:209], v144 offset:4096
    ds_read_b64_tr_b16 v[210:211], v144 offset:4608
    ds_read_b64_tr_b16 v[212:213], v145 offset:4096
    ds_read_b64_tr_b16 v[214:215], v145 offset:4608
    ds_read_b64_tr_b16 v[216:217], v146 offset:4096
    ds_read_b64_tr_b16 v[218:219], v146 offset:4608
    ds_read_b64_tr_b16 v[220:221], v147 offset:4096
    ds_read_b64_tr_b16 v[222:223], v147 offset:4608
    s_mov_b64 exec, 1
    v_mov_b32 v2, 1
    buffer_store_dword v2, off, s[20:23], s86 sc1
    s_mov_b64 exec, -1
    s_waitcnt lgkmcnt(8)
    v_mfma_f32_16x16x32_bf16 v[240:243], v[192:195], v[48:51], 0
    ds_read_b64_tr_b16 v[224:225], v144 offset:8192
    ds_read_b64_tr_b16 v[226:227], v144 offset:8704
    v_mfma_f32_16x16x32_bf16 v[244:247], v[196:199], v[48:51], 0
    ds_read_b64_tr_b16 v[228:229], v145 offset:8192
    ds_read_b64_tr_b16 v[230:231], v145 offset:8704
    v_mfma_f32_16x16x32_bf16 v[248:251], v[200:203], v[48:51], 0
    ds_read_b64_tr_b16 v[232:233], v146 offset:8192
    ds_read_b64_tr_b16 v[234:235], v146 offset:8704
    v_mfma_f32_16x16x32_bf16 v[252:255], v[204:207], v[48:51], 0
    ds_read_b64_tr_b16 v[236:237], v147 offset:8192
    ds_read_b64_tr_b16 v[238:239], v147 offset:8704
    v_mfma_f32_16x16x32_bf16 v[160:163], v[192:195], v[176:179], 0
    s_mov_b32 m0, s87
    s_nop 0
    buffer_load_dwordx4 v19, s[24:27], 0 offen nt lds
    s_waitcnt lgkmcnt(8)
    v_mfma_f32_16x16x32_bf16 v[240:243], v[208:211], v[52:55], v[240:243]
    ds_read_b64_tr_b16 v[192:193], v144 offset:12288
    ds_read_b64_tr_b16 v[194:195], v144 offset:12800
    v_mfma_f32_16x16x32_bf16 v[244:247], v[212:215], v[52:55], v[244:247]
    ds_read_b64_tr_b16 v[196:197], v145 offset:12288
    ds_read_b64_tr_b16 v[198:199], v145 offset:12800
    v_mfma_f32_16x16x32_bf16 v[248:251], v[216:219], v[52:55], v[248:251]
    ds_read_b64_tr_b16 v[200:201], v146 offset:12288
    ds_read_b64_tr_b16 v[202:203], v146 offset:12800
    v_mfma_f32_16x16x32_bf16 v[252:255], v[220:223], v[52:55], v[252:255]
    ds_read_b64_tr_b16 v[204:205], v147 offset:12288
    ds_read_b64_tr_b16 v[206:207], v147 offset:12800
    v_mfma_f32_16x16x32_bf16 v[160:163], v[208:211], v[176:179], v[160:163]
    s_add_u32 m0, s78, 132096
    s_nop 0
    buffer_load_dwordx4 v18, s[24:27], s76 offen offset:0 nt lds
    s_waitcnt lgkmcnt(8)
    v_mfma_f32_16x16x32_bf16 v[240:243], v[224:227], v[56:59], v[240:243]
    ds_read_b64_tr_b16 v[208:209], v144 offset:16384
    ds_read_b64_tr_b16 v[210:211], v144 offset:16896
    v_mfma_f32_16x16x32_bf16 v[244:247], v[228:231], v[56:59], v[244:247]
    ds_read_b64_tr_b16 v[212:213], v145 offset:16384
    ds_read_b64_tr_b16 v[214:215], v145 offset:16896
    v_mfma_f32_16x16x32_bf16 v[248:251], v[232:235], v[56:59], v[248:251]
    ds_read_b64_tr_b16 v[216:217], v146 offset:16384
    ds_read_b64_tr_b16 v[218:219], v146 offset:16896
    v_mfma_f32_16x16x32_bf16 v[252:255], v[236:239], v[56:59], v[252:255]
    ds_read_b64_tr_b16 v[220:221], v147 offset:16384
    ds_read_b64_tr_b16 v[222:223], v147 offset:16896
    v_mfma_f32_16x16x32_bf16 v[160:163], v[224:227], v[176:179], v[160:163]
    buffer_load_dwordx4 v18, s[24:27], s77 offen offset:1024 nt lds
    s_waitcnt lgkmcnt(8)
    v_mfma_f32_16x16x32_bf16 v[240:243], v[192:195], v[60:63], v[240:243]
    ds_read_b64_tr_b16 v[224:225], v144 offset:20480
    ds_read_b64_tr_b16 v[226:227], v144 offset:20992
    v_mfma_f32_16x16x32_bf16 v[244:247], v[196:199], v[60:63], v[244:247]
    ds_read_b64_tr_b16 v[228:229], v145 offset:20480
    ds_read_b64_tr_b16 v[230:231], v145 offset:20992
    v_mfma_f32_16x16x32_bf16 v[248:251], v[200:203], v[60:63], v[248:251]
    ds_read_b64_tr_b16 v[232:233], v146 offset:20480
    ds_read_b64_tr_b16 v[234:235], v146 offset:20992
    v_mfma_f32_16x16x32_bf16 v[252:255], v[204:207], v[60:63], v[252:255]
    ds_read_b64_tr_b16 v[236:237], v147 offset:20480
    ds_read_b64_tr_b16 v[238:239], v147 offset:20992
    v_mfma_f32_16x16x32_bf16 v[160:163], v[192:195], v[176:179], v[160:163]
    s_add_u32 m0, s78, 140288
    s_nop 0
    buffer_load_dwordx4 v20, s[28:31], s76 offen offset:0 nt lds
    s_waitcnt lgkmcnt(8)
    v_mfma_f32_16x16x32_bf16 v[240:243], v[208:211], v[64:67], v[240:243]
    ds_read_b64_tr_b16 v[192:193], v144 offset:24576
    ds_read_b64_tr_b16 v[194:195], v144 offset:25088
    v_mfma_f32_16x16x32_bf16 v[244:247], v[212:215], v[64:67], v[244:247]
    ds_read_b64_tr_b16 v[196:197], v145 offset:24576
    ds_read_b64_tr_b16 v[198:199], v145 offset:25088
    v_mfma_f32_16x16x32_bf16 v[248:251], v[216:219], v[64:67], v[248:251]
    ds_read_b64_tr_b16 v[200:201], v146 offset:24576
    ds_read_b64_tr_b16 v[202:203], v146 offset:25088
    v_mfma_f32_16x16x32_bf16 v[252:255], v[220:223], v[64:67], v[252:255]
    ds_read_b64_tr_b16 v[204:205], v147 offset:24576
    ds_read_b64_tr_b16 v[206:207], v147 offset:25088
    v_mfma_f32_16x16x32_bf16 v[160:163], v[208:211], v[176:179], v[160:163]
    buffer_load_dwordx4 v21, s[28:31], s77 offen offset:1024 nt lds
    s_waitcnt lgkmcnt(8)
    v_mfma_f32_16x16x32_bf16 v[240:243], v[224:227], v[68:71], v[240:243]
    ds_read_b64_tr_b16 v[208:209], v144 offset:28672
    ds_read_b64_tr_b16 v[210:211], v144 offset:29184
    v_mfma_f32_16x16x32_bf16 v[244:247], v[228:231], v[68:71], v[244:247]
    ds_read_b64_tr_b16 v[212:213], v145 offset:28672
    ds_read_b64_tr_b16 v[214:215], v145 offset:29184
    v_mfma_f32_16x16x32_bf16 v[248:251], v[232:235], v[68:71], v[248:251]
    ds_read_b64_tr_b16 v[216:217], v146 offset:28672
    ds_read_b64_tr_b16 v[218:219], v146 offset:29184
    v_mfma_f32_16x16x32_bf16 v[252:255], v[236:239], v[68:71], v[252:255]
    ds_read_b64_tr_b16 v[220:221], v147 offset:28672
    ds_read_b64_tr_b16 v[222:223], v147 offset:29184
    v_mfma_f32_16x16x32_bf16 v[160:163], v[224:227], v[176:179], v[160:163]
    buffer_load_dwordx2 v[30:31], v22, s[32:35], s88 offen
    s_waitcnt vmcnt(8)
    s_barrier
    s_waitcnt lgkmcnt(8)
    v_mfma_f32_16x16x32_bf16 v[240:243], v[192:195], v[72:75], v[240:243]
    ds_read_b64_tr_b16 v[224:225], v144 offset:32768
    ds_read_b64_tr_b16 v[226:227], v144 offset:33280
    v_mfma_f32_16x16x32_bf16 v[244:247], v[196:199], v[72:75], v[244:247]
    ds_read_b64_tr_b16 v[228:229], v145 offset:32768
    ds_read_b64_tr_b16 v[230:231], v145 offset:33280
    v_mfma_f32_16x16x32_bf16 v[248:251], v[200:203], v[72:75], v[248:251]
    ds_read_b64_tr_b16 v[232:233], v146 offset:32768
    ds_read_b64_tr_b16 v[234:235], v146 offset:33280
    v_mfma_f32_16x16x32_bf16 v[252:255], v[204:207], v[72:75], v[252:255]
    ds_read_b64_tr_b16 v[236:237], v147 offset:32768
    ds_read_b64_tr_b16 v[238:239], v147 offset:33280
    v_mfma_f32_16x16x32_bf16 v[160:163], v[192:195], v[176:179], v[160:163]
    s_mov_b32 m0, s89
    s_nop 0
    buffer_load_dwordx4 v14, s[4:7], s76 offen offset:0  lds
    s_waitcnt lgkmcnt(8)
    v_mfma_f32_16x16x32_bf16 v[240:243], v[208:211], v[76:79], v[240:243]
    ds_read_b64_tr_b16 v[192:193], v144 offset:36864
    ds_read_b64_tr_b16 v[194:195], v144 offset:37376
    v_mfma_f32_16x16x32_bf16 v[244:247], v[212:215], v[76:79], v[244:247]
    ds_read_b64_tr_b16 v[196:197], v145 offset:36864
    ds_read_b64_tr_b16 v[198:199], v145 offset:37376
    v_mfma_f32_16x16x32_bf16 v[248:251], v[216:219], v[76:79], v[248:251]
    ds_read_b64_tr_b16 v[200:201], v146 offset:36864
    ds_read_b64_tr_b16 v[202:203], v146 offset:37376
    v_mfma_f32_16x16x32_bf16 v[252:255], v[220:223], v[76:79], v[252:255]
    ds_read_b64_tr_b16 v[204:205], v147 offset:36864
    ds_read_b64_tr_b16 v[206:207], v147 offset:37376
    v_mfma_f32_16x16x32_bf16 v[160:163], v[208:211], v[176:179], v[160:163]
    buffer_load_dwordx4 v15, s[4:7], s76 offen offset:1024  lds
    s_waitcnt lgkmcnt(8)
    v_mfma_f32_16x16x32_bf16 v[240:243], v[224:227], v[80:83], v[240:243]
    ds_read_b64_tr_b16 v[208:209], v144 offset:40960
    ds_read_b64_tr_b16 v[210:211], v144 offset:41472
    v_mfma_f32_16x16x32_bf16 v[244:247], v[228:231], v[80:83], v[244:247]
    ds_read_b64_tr_b16 v[212:213], v145 offset:40960
    ds_read_b64_tr_b16 v[214:215], v145 offset:41472
    v_mfma_f32_16x16x32_bf16 v[248:251], v[232:235], v[80:83], v[248:251]
    ds_read_b64_tr_b16 v[216:217], v146 offset:40960
    ds_read_b64_tr_b16 v[218:219], v146 offset:41472
    v_mfma_f32_16x16x32_bf16 v[252:255], v[236:239], v[80:83], v[252:255]
    ds_read_b64_tr_b16 v[220:221], v147 offset:40960
    ds_read_b64_tr_b16 v[222:223], v147 offset:41472
    v_mfma_f32_16x16x32_bf16 v[160:163], v[224:227], v[176:179], v[160:163]
    buffer_load_dwordx2 v[136:137], v8, s[40:43], s74 offen offset:0
    s_waitcnt lgkmcnt(8)
    v_mfma_f32_16x16x32_bf16 v[240:243], v[192:195], v[84:87], v[240:243]
    ds_read_b64_tr_b16 v[224:225], v144 offset:45056
    ds_read_b64_tr_b16 v[226:227], v144 offset:45568
    v_mfma_f32_16x16x32_bf16 v[244:247], v[196:199], v[84:87], v[244:247]
    ds_read_b64_tr_b16 v[228:229], v145 offset:45056
    ds_read_b64_tr_b16 v[230:231], v145 offset:45568
    v_mfma_f32_16x16x32_bf16 v[248:251], v[200:203], v[84:87], v[248:251]
    ds_read_b64_tr_b16 v[232:233], v146 offset:45056
    ds_read_b64_tr_b16 v[234:235], v146 offset:45568
    v_mfma_f32_16x16x32_bf16 v[252:255], v[204:207], v[84:87], v[252:255]
    ds_read_b64_tr_b16 v[236:237], v147 offset:45056
    ds_read_b64_tr_b16 v[238:239], v147 offset:45568
    v_mfma_f32_16x16x32_bf16 v[160:163], v[192:195], v[176:179], v[160:163]
    buffer_load_dwordx2 v[138:139], v8, s[40:43], s74 offen offset:32
    s_waitcnt lgkmcnt(8)
    v_mfma_f32_16x16x32_bf16 v[240:243], v[208:211], v[88:91], v[240:243]
    ds_read_b64_tr_b16 v[192:193], v144 offset:49152
    ds_read_b64_tr_b16 v[194:195], v144 offset:49664
    v_mfma_f32_16x16x32_bf16 v[244:247], v[212:215], v[88:91], v[244:247]
    ds_read_b64_tr_b16 v[196:197], v145 offset:49152
    ds_read_b64_tr_b16 v[198:199], v145 offset:49664
    v_mfma_f32_16x16x32_bf16 v[248:251], v[216:219], v[88:91], v[248:251]
    ds_read_b64_tr_b16 v[200:201], v146 offset:49152
    ds_read_b64_tr_b16 v[202:203], v146 offset:49664
    v_mfma_f32_16x16x32_bf16 v[252:255], v[220:223], v[88:91], v[252:255]
    ds_read_b64_tr_b16 v[204:205], v147 offset:49152
    ds_read_b64_tr_b16 v[206:207], v147 offset:49664
    v_mfma_f32_16x16x32_bf16 v[160:163], v[208:211], v[176:179], v[160:163]
    buffer_load_dwordx2 v[140:141], v8, s[40:43], s74 offen offset:64
    s_waitcnt lgkmcnt(8)
    v_mfma_f32_16x16x32_bf16 v[240:243], v[224:227], v[92:95], v[240:243]
    ds_read_b64_tr_b16 v[208:209], v144 offset:53248
    ds_read_b64_tr_b16 v[210:211], v144 offset:53760
    v_mfma_f32_16x16x32_bf16 v[244:247], v[228:231], v[92:95], v[244:247]
    ds_read_b64_tr_b16 v[212:213], v145 offset:53248
    ds_read_b64_tr_b16 v[214:215], v145 offset:53760
    v_mfma_f32_16x16x32_bf16 v[248:251], v[232:235], v[92:95], v[248:251]
    ds_read_b64_tr_b16 v[216:217], v146 offset:53248
    ds_read_b64_tr_b16 v[218:219], v146 offset:53760
    v_mfma_f32_16x16x32_bf16 v[252:255], v[236:239], v[92:95], v[252:255]
    ds_read_b64_tr_b16 v[220:221], v147 offset:53248
    ds_read_b64_tr_b16 v[222:223], v147 offset:53760
    v_mfma_f32_16x16x32_bf16 v[160:163], v[224:227], v[176:179], v[160:163]
    buffer_load_dwordx2 v[142:143], v8, s[40:43], s74 offen offset:96
    s_waitcnt lgkmcnt(8)
    v_mfma_f32_16x16x32_bf16 v[240:243], v[192:195], v[96:99], v[240:243]
    ds_read_b64_tr_b16 v[224:225], v144 offset:57344
    ds_read_b64_tr_b16 v[226:227], v144 offset:57856
    v_mfma_f32_16x16x32_bf16 v[244:247], v[196:199], v[96:99], v[244:247]
    ds_read_b64_tr_b16 v[228:229], v145 offset:57344
    ds_read_b64_tr_b16 v[230:231], v145 offset:57856
    v_mfma_f32_16x16x32_bf16 v[248:251], v[200:203], v[96:99], v[248:251]
    ds_read_b64_tr_b16 v[232:233], v146 offset:57344
    ds_read_b64_tr_b16 v[234:235], v146 offset:57856
    v_mfma_f32_16x16x32_bf16 v[252:255], v[204:207], v[96:99], v[252:255]
    ds_read_b64_tr_b16 v[236:237], v147 offset:57344
    ds_read_b64_tr_b16 v[238:239], v147 offset:57856
    v_mfma_f32_16x16x32_bf16 v[160:163], v[192:195], v[176:179], v[160:163]
    buffer_load_short_d16_hi v16, off, s[36:39], s67
    s_waitcnt lgkmcnt(8)
    v_mfma_f32_16x16x32_bf16 v[240:243], v[208:211], v[100:103], v[240:243]
    ds_read_b64_tr_b16 v[192:193], v144 offset:61440
    ds_read_b64_tr_b16 v[194:195], v144 offset:61952
    v_mfma_f32_16x16x32_bf16 v[244:247], v[212:215], v[100:103], v[244:247]
    ds_read_b64_tr_b16 v[196:197], v145 offset:61440
    ds_read_b64_tr_b16 v[198:199], v145 offset:61952
    v_mfma_f32_16x16x32_bf16 v[248:251], v[216:219], v[100:103], v[248:251]
    ds_read_b64_tr_b16 v[200:201], v146 offset:61440
    ds_read_b64_tr_b16 v[202:203], v146 offset:61952
    v_mfma_f32_16x16x32_bf16 v[252:255], v[220:223], v[100:103], v[252:255]
    ds_read_b64_tr_b16 v[204:205], v147 offset:61440
    ds_read_b64_tr_b16 v[206:207], v147 offset:61952
    v_mfma_f32_16x16x32_bf16 v[160:163], v[208:211], v[176:179], v[160:163]
    s_xor_b32 m0, s79, 0
    s_xor_b32 s81, s80, 0
    buffer_load_dwordx4 v152, s[16:19], s81 offen offset:0 lds
    s_waitcnt lgkmcnt(8)
    v_mfma_f32_16x16x32_bf16 v[240:243], v[224:227], v[104:107], v[240:243]
    v_mfma_f32_16x16x32_bf16 v[244:247], v[228:231], v[104:107], v[244:247]
    v_mfma_f32_16x16x32_bf16 v[248:251], v[232:235], v[104:107], v[248:251]
    v_mfma_f32_16x16x32_bf16 v[252:255], v[236:239], v[104:107], v[252:255]
    v_mfma_f32_16x16x32_bf16 v[160:163], v[224:227], v[176:179], v[160:163]
    buffer_load_dwordx4 v153, s[16:19], s81 offen offset:1024 lds
    s_waitcnt lgkmcnt(0)
    v_mfma_f32_16x16x32_bf16 v[240:243], v[192:195], v[108:111], v[240:243]
    v_mfma_f32_16x16x32_bf16 v[244:247], v[196:199], v[108:111], v[244:247]
    v_mfma_f32_16x16x32_bf16 v[248:251], v[200:203], v[108:111], v[248:251]
    v_mfma_f32_16x16x32_bf16 v[252:255], v[204:207], v[108:111], v[252:255]
    v_mfma_f32_16x16x32_bf16 v[160:163], v[192:195], v[176:179], v[160:163]
    buffer_load_dwordx4 v154, s[16:19], s81 offen offset:2048 lds
    s_nop 6
    ds_write_b128 v38, v[160:163]
    v_fmac_f32 v240, v121, v160
    v_fmac_f32 v241, v121, v161
    v_fmac_f32 v242, v121, v162
    v_fmac_f32 v243, v121, v163
    s_waitcnt lgkmcnt(0)
    s_barrier
    v_xor_b32_e64 v6, 64, v38
    ds_read_b128 v[164:167], v6
    v_xor_b32 v6, 128, v38
    ds_read_b128 v[168:171], v6
    v_xor_b32 v6, 192, v38
    ds_read_b128 v[172:175], v6
    s_waitcnt lgkmcnt(2)
    buffer_load_dwordx4 v155, s[16:19], s81 offen offset:3072 lds
    v_fmac_f32 v244, v121, v164
    v_fmac_f32 v245, v121, v165
    v_fmac_f32 v246, v121, v166
    v_fmac_f32 v247, v121, v167
    s_waitcnt lgkmcnt(1)
    v_fmac_f32 v248, v121, v168
    v_fmac_f32 v249, v121, v169
    v_fmac_f32 v250, v121, v170
    v_fmac_f32 v251, v121, v171
    s_xor_b32 m0, s79, 4096
    s_xor_b32 s81, s80, 32768
    buffer_load_dwordx4 v152, s[16:19], s81 offen offset:0 lds
    s_waitcnt lgkmcnt(0)
    v_fmac_f32 v252, v121, v172
    v_fmac_f32 v253, v121, v173
    v_fmac_f32 v254, v121, v174
    v_fmac_f32 v255, v121, v175
    v_pk_mul_f32 v[112:113], v[240:241], v[240:241]
    v_pk_mul_f32 v[114:115], v[242:243], v[242:243]
    v_pk_mul_f32 v[116:117], v[244:245], v[244:245]
    v_pk_mul_f32 v[118:119], v[246:247], v[246:247]
    v_pk_fma_f32 v[112:113], v[112:113], v[124:125], v[124:125] op_sel:[0,0,1] op_sel_hi:[1,0,1]
    v_pk_fma_f32 v[114:115], v[114:115], v[124:125], v[124:125] op_sel:[0,0,1] op_sel_hi:[1,0,1]
    v_pk_fma_f32 v[116:117], v[116:117], v[124:125], v[124:125] op_sel:[0,0,1] op_sel_hi:[1,0,1]
    v_pk_fma_f32 v[118:119], v[118:119], v[124:125], v[124:125] op_sel:[0,0,1] op_sel_hi:[1,0,1]
    buffer_load_dwordx4 v153, s[16:19], s81 offen offset:1024 lds
    v_pk_mul_f32 v[112:113], v[112:113], v[240:241]
    v_pk_mul_f32 v[114:115], v[114:115], v[242:243]
    v_pk_mul_f32 v[116:117], v[116:117], v[244:245]
    v_pk_mul_f32 v[118:119], v[118:119], v[246:247]
    v_exp_f32 v112, v112
    v_exp_f32 v113, v113
    v_exp_f32 v114, v114
    v_exp_f32 v115, v115
    v_exp_f32 v116, v116
    v_exp_f32 v117, v117
    buffer_load_dwordx4 v154, s[16:19], s81 offen offset:2048 lds
    v_exp_f32 v118, v118
    v_exp_f32_e64 v119, v119
    v_pk_fma_f32 v[112:113], v[112:113], v[126:127], v[126:127] op_sel_hi:[1,0,0]
    v_pk_fma_f32 v[114:115], v[114:115], v[126:127], v[126:127] op_sel_hi:[1,0,0]
    v_pk_fma_f32 v[116:117], v[116:117], v[126:127], v[126:127] op_sel_hi:[1,0,0]
    v_pk_fma_f32 v[118:119], v[118:119], v[126:127], v[126:127] op_sel_hi:[1,0,0]
    v_rcp_f32 v112, v112
    v_rcp_f32 v113, v113
    v_rcp_f32 v114, v114
    v_rcp_f32 v115, v115
    v_rcp_f32 v116, v116
    buffer_load_dwordx4 v155, s[16:19], s81 offen offset:3072 lds
    v_rcp_f32 v117, v117
    v_rcp_f32 v118, v118
    v_rcp_f32 v119, v119
    v_pk_mul_f32 v[112:113], v[112:113], v[240:241]
    v_pk_mul_f32 v[114:115], v[114:115], v[242:243]
    v_pk_mul_f32 v[116:117], v[116:117], v[244:245]
    v_pk_mul_f32 v[118:119], v[118:119], v[246:247]
    v_cvt_pk_bf16_f32 v128, v112, v113
    v_cvt_pk_bf16_f32 v129, v114, v115
    v_cvt_pk_bf16_f32 v130, v116, v117
    v_cvt_pk_bf16_f32 v131, v118, v119
    buffer_load_dword v17, v13, s[20:23], 0 offen sc1
    buffer_store_dwordx4 v[128:131], v3, s[8:11], s92 offen sc1
    v_pk_mul_f32 v[112:113], v[248:249], v[248:249]
    v_pk_mul_f32 v[114:115], v[250:251], v[250:251]
    v_pk_mul_f32 v[116:117], v[252:253], v[252:253]
    v_pk_mul_f32 v[118:119], v[254:255], v[254:255]
    v_pk_fma_f32 v[112:113], v[112:113], v[124:125], v[124:125] op_sel:[0,0,1] op_sel_hi:[1,0,1]
    v_pk_fma_f32 v[114:115], v[114:115], v[124:125], v[124:125] op_sel:[0,0,1] op_sel_hi:[1,0,1]
    v_pk_fma_f32 v[116:117], v[116:117], v[124:125], v[124:125] op_sel:[0,0,1] op_sel_hi:[1,0,1]
    v_pk_fma_f32 v[118:119], v[118:119], v[124:125], v[124:125] op_sel:[0,0,1] op_sel_hi:[1,0,1]
    v_pk_mul_f32 v[112:113], v[112:113], v[248:249]
    v_pk_mul_f32 v[114:115], v[114:115], v[250:251]
    v_pk_mul_f32 v[116:117], v[116:117], v[252:253]
    v_pk_mul_f32 v[118:119], v[118:119], v[254:255]
    v_exp_f32 v112, v112
    v_exp_f32 v113, v113
    v_exp_f32 v114, v114
    v_exp_f32 v115, v115
    v_exp_f32 v116, v116
    v_exp_f32 v117, v117
    v_exp_f32 v118, v118
    v_exp_f32 v119, v119
    v_pk_fma_f32 v[112:113], v[112:113], v[126:127], v[126:127] op_sel_hi:[1,0,0]
    v_pk_fma_f32 v[114:115], v[114:115], v[126:127], v[126:127] op_sel_hi:[1,0,0]
    s_xor_b32 m0, s79, 8192
    s_xor_b32 s81, s80, 65536
    buffer_load_dwordx4 v152, s[16:19], s81 offen offset:0 lds
    v_pk_fma_f32 v[116:117], v[116:117], v[126:127], v[126:127] op_sel_hi:[1,0,0]
    v_pk_fma_f32 v[118:119], v[118:119], v[126:127], v[126:127] op_sel_hi:[1,0,0]
    v_rcp_f32 v112, v112
    v_rcp_f32 v113, v113
    v_rcp_f32 v114, v114
    v_rcp_f32 v115, v115
    v_rcp_f32 v116, v116
    v_rcp_f32 v117, v117
    v_rcp_f32 v118, v118
    v_rcp_f32 v119, v119
    v_pk_mul_f32 v[112:113], v[112:113], v[248:249]
    buffer_load_dwordx4 v153, s[16:19], s81 offen offset:1024 lds
    v_pk_mul_f32 v[114:115], v[114:115], v[250:251]
    v_pk_mul_f32 v[116:117], v[116:117], v[252:253]
    v_pk_mul_f32 v[118:119], v[118:119], v[254:255]
    v_cvt_pk_bf16_f32 v132, v112, v113
    v_cvt_pk_bf16_f32 v133, v114, v115
    v_cvt_pk_bf16_f32 v134, v116, v117
    v_cvt_pk_bf16_f32 v135, v118, v119
    buffer_store_dwordx4 v[132:135], v3, s[8:11], s93 offen sc1
    v_lshrrev_b32 v6, 1, v9
    v_lshrrev_b32 v7, 1, v10
    v_xor_b32 v6, v6, v7
    v_lshlrev_b32 v6, 4, v6
    v_lshl_add_u32 v6, v9, 7, v6
    v_and_b32 v7, 1, v10
    v_lshl_add_u32 v6, v7, 3, v6
    v_add_u32 v6, s89, v6
    s_waitcnt vmcnt(13)
    s_barrier
    v_xor_b32 v7, 0, v6
    ds_read_b64 v[120:121], v7
    v_xor_b32 v7, 32, v6
    ds_read_b64 v[122:123], v7
    v_xor_b32_e64 v7, 64, v6
    ds_read_b64 v[124:125], v7
    v_xor_b32 v7, 96, v6
    ds_read_b64 v[126:127], v7
    ds_read_b64_tr_b16 v[80:81], v26 offset:0
    ds_read_b64_tr_b16 v[48:49], v24 offset:0
    ds_read_b64_tr_b16 v[50:51], v25 offset:0
    ds_read_b64_tr_b16 v[52:53], v24 offset:1024
    ds_read_b64_tr_b16 v[54:55], v25 offset:1024
    ds_read_b64_tr_b16 v[82:83], v26 offset:2048
    ds_read_b64_tr_b16 v[56:57], v24 offset:2048
    ds_read_b64_tr_b16 v[58:59], v25 offset:2048
    ds_read_b64_tr_b16 v[60:61], v24 offset:3072
    ds_read_b64_tr_b16 v[62:63], v25 offset:3072
    s_waitcnt lgkmcnt(5)
    buffer_load_dwordx4 v154, s[16:19], s81 offen offset:2048 lds
    ds_read_b64_tr_b16 v[84:85], v26 offset:4096
    ds_read_b64_tr_b16 v[64:65], v24 offset:4096
    ds_read_b64_tr_b16 v[66:67], v25 offset:4096
    ds_read_b64_tr_b16 v[68:69], v24 offset:5120
    ds_read_b64_tr_b16 v[70:71], v25 offset:5120
    v_dot2_f32_bf16 v88, v48, v30, 0
    v_dot2_f32_bf16 v89, v50, v30, 0
    v_dot2_f32_bf16 v90, v52, v30, 0
    v_dot2_f32_bf16 v91, v54, v30, 0
    buffer_load_dwordx4 v155, s[16:19], s81 offen offset:3072 lds
    v_dot2_f32_bf16 v88, v49, v31, v88
    v_dot2_f32_bf16 v89, v51, v31, v89
    v_dot2_f32_bf16 v90, v53, v31, v90
    v_dot2_f32_bf16 v91, v55, v31, v91
    v_lshlrev_b32 v112, 16, v80
    v_and_b32 v113, s71, v80
    v_lshlrev_b32 v114, 16, v81
    v_and_b32_e64 v115, s71, v81
    v_pk_mul_f32 v[112:113], v[112:113], v[88:89]
    v_pk_mul_f32 v[114:115], v[114:115], v[90:91]
    v_cvt_pk_bf16_f32 v160, v112, v113
    v_cvt_pk_bf16_f32 v161, v114, v115
    s_waitcnt lgkmcnt(5)
    ds_read_b64_tr_b16 v[86:87], v26 offset:6144
    ds_read_b64_tr_b16 v[72:73], v24 offset:6144
    ds_read_b64_tr_b16 v[74:75], v25 offset:6144
    ds_read_b64_tr_b16 v[76:77], v24 offset:7168
    ds_read_b64_tr_b16 v[78:79], v25 offset:7168
    v_dot2_f32_bf16 v92, v56, v30, 0
    s_xor_b32 m0, s79, 12288
    s_xor_b32 s81, s80, 98304
    buffer_load_dwordx4 v152, s[16:19], s81 offen offset:0 lds
    v_dot2_f32_bf16 v93, v58, v30, 0
    v_dot2_f32_bf16 v94, v60, v30, 0
    v_dot2_f32_bf16 v95, v62, v30, 0
    v_dot2_f32_bf16 v92, v57, v31, v92
    v_dot2_f32_bf16 v93, v59, v31, v93
    v_dot2_f32_bf16 v94, v61, v31, v94
    v_dot2_f32_bf16 v95, v63, v31, v95
    v_lshlrev_b32 v112, 16, v82
    v_and_b32 v113, s71, v82
    v_lshlrev_b32 v114, 16, v83
    v_and_b32_e64 v115, s71, v83
    v_pk_mul_f32 v[112:113], v[112:113], v[92:93]
    v_pk_mul_f32 v[114:115], v[114:115], v[94:95]
    v_cvt_pk_bf16_f32 v162, v112, v113
    v_cvt_pk_bf16_f32 v163, v114, v115
    ds_write_b128 v28, v[160:163]
    v_xor_b32 v28, 16, v28
    s_waitcnt lgkmcnt(6)
    buffer_load_dwordx4 v153, s[16:19], s81 offen offset:1024 lds
    v_dot2_f32_bf16 v96, v64, v30, 0
    v_dot2_f32_bf16 v97, v66, v30, 0
    v_dot2_f32_bf16 v98, v68, v30, 0
    v_dot2_f32_bf16 v99, v70, v30, 0
    v_dot2_f32_bf16 v96, v65, v31, v96
    v_dot2_f32_bf16 v97, v67, v31, v97
    v_dot2_f32_bf16 v98, v69, v31, v98
    v_dot2_f32_bf16 v99, v71, v31, v99
    v_lshlrev_b32 v112, 16, v84
    v_and_b32 v113, s71, v84
    v_lshlrev_b32 v114, 16, v85
    v_and_b32 v115, s71, v85
    v_pk_mul_f32 v[112:113], v[112:113], v[96:97]
    v_pk_mul_f32 v[114:115], v[114:115], v[98:99]
    v_cvt_pk_bf16_f32 v164, v112, v113
    v_cvt_pk_bf16_f32 v165, v114, v115
    s_waitcnt vmcnt(8)
    v_cmp_gt_u32 vcc, 1, v17
    s_cbranch_vccnz chk_2_slow
chk_2_ok:
    buffer_load_dword v5, off, s[8:11], s84 sc1
    buffer_load_dwordx4 v154, s[16:19], s81 offen offset:2048 lds
    s_waitcnt vmcnt(6)
    buffer_load_dwordx4 v155, s[16:19], s81 offen offset:3072 lds
    s_mov_b64 exec, 1
    v_mov_b32 v2, 1
    buffer_store_dword v2, off, s[8:11], s85
    buffer_store_dword v2, off, s[8:11], s83 sc1
    s_mov_b64 exec, -1
    s_waitcnt lgkmcnt(1)
    s_add_u32 s99, s95, 0
    v_dot2_f32_bf16 v100, v72, v30, 0
    v_dot2_f32_bf16 v101, v74, v30, 0
    v_dot2_f32_bf16 v102, v76, v30, 0
    v_dot2_f32_bf16 v103, v78, v30, 0
    v_dot2_f32_bf16 v100, v73, v31, v100
    v_dot2_f32_bf16 v101, v75, v31, v101
    v_dot2_f32_bf16 v102, v77, v31, v102
    v_dot2_f32_bf16 v103, v79, v31, v103
    v_lshlrev_b32 v112, 16, v86
    v_and_b32 v113, s71, v86
    v_lshlrev_b32 v114, 16, v87
    v_and_b32 v115, s71, v87
    v_pk_mul_f32 v[112:113], v[112:113], v[100:101]
    v_pk_mul_f32 v[114:115], v[114:115], v[102:103]
    s_add_u32 m0, s98, 0
    s_nop 0
    buffer_load_dwordx4 v32, s[44:47], s99 offen offset:0  lds
    v_cvt_pk_bf16_f32 v166, v112, v113
    v_cvt_pk_bf16_f32 v167, v114, v115
    ds_write_b128 v28, v[164:167]
    s_lshl_b32 s64, s60, 18
    s_lshl_b32 s65, s3, 16
    s_add_u32 s4, s64, s65
    s_lshl_b32 s64, s61, 7
    s_add_u32 s4, s4, s64
    s_add_u32 s64, s4, 5242880
    s_add_u32 s65, s4, 5275648
    s_waitcnt lgkmcnt(0)
    buffer_load_dwordx4 v33, s[44:47], s99 offen offset:1024  lds
    ds_read_b128 v[160:163], v29
    ds_read_b128 v[164:167], v29 offset:1024
    s_waitcnt lgkmcnt(0)
    buffer_load_dwordx4 v34, s[44:47], s99 offen offset:2048  lds
    buffer_store_dwordx4 v[160:163], v27, s[8:11], s64 offen sc1
    buffer_store_dwordx4 v[164:167], v27, s[8:11], s65 offen sc1
    v_lshl_add_u32 v6, v10, 2, v11
    v_bfe_u32 v7, v6, 1, 2
    v_lshl_add_u32 v6, v6, 7, v23
    s_and_b32 s64, s3, 1
    s_lshl_b32 s64, s64, 11
    v_lshl_add_u32 v6, v7, 5, v6
    v_add_u32 v144, s64, v6
    v_xor_b32 v145, 2048, v144
    v_xor_b32 v146, 32, v144
    v_xor_b32 v147, 2080, v144
    v_xor_b32_e64 v148, 64, v144
    v_xor_b32 v149, 2112, v144
    v_xor_b32 v150, 96, v144
    v_xor_b32 v151, 2144, v144
    s_lshl_b32 s64, s3, 2
    v_lshl_add_u32 v14, v12, 4, s64
    s_lshr_b32 s66, s3, 1
    s_and_b32 s67, s3, 1
    s_mul_i32 s5, s66, 4224
    s_add_u32 s5, s5, 131072
    s_mul_i32 s6, s66, 4608
    s_add_u32 s6, s6, 139520
    s_lshl_b32 s65, s90, 12
    buffer_load_dwordx4 v35, s[44:47], s99 offen offset:3072  lds
    s_add_u32 s99, s95, 114688
    s_add_u32 m0, s98, 4096
    s_nop 0
    buffer_load_dwordx4 v32, s[44:47], s99 offen offset:0  lds
    buffer_load_dwordx4 v33, s[44:47], s99 offen offset:1024  lds
    buffer_load_dwordx4 v34, s[44:47], s99 offen offset:2048  lds
    buffer_load_dwordx4 v35, s[44:47], s99 offen offset:3072  lds
    s_waitcnt vmcnt(12)
    s_barrier
    s_add_u32 m0, s5, 32
    s_nop 0
    ds_read_b64_tr_b16 a[128:129], v144 offset:32768
    ds_read_b64_tr_b16 a[130:131], v145 offset:32768
    ds_read_b64_tr_b16 a[132:133], v146 offset:32768
    ds_read_b64_tr_b16 a[134:135], v147 offset:32768
    ds_read_b64_tr_b16 a[136:137], v148 offset:32768
    ds_read_b64_tr_b16 a[138:139], v149 offset:32768
    ds_read_b64_tr_b16 a[140:141], v150 offset:32768
    ds_read_b64_tr_b16 a[142:143], v151 offset:32768
    buffer_load_dword v15, v14, s[8:11], s84 offen sc1
    ds_read_b64_tr_b16 a[144:145], v144 offset:36864
    ds_read_b64_tr_b16 a[146:147], v145 offset:36864
    ds_read_b64_tr_b16 a[148:149], v146 offset:36864
    ds_read_b64_tr_b16 a[150:151], v147 offset:36864
    ds_read_b64_tr_b16 a[152:153], v148 offset:36864
    ds_read_b64_tr_b16 a[154:155], v149 offset:36864
    ds_read_b64_tr_b16 a[156:157], v150 offset:36864
    ds_read_b64_tr_b16 a[158:159], v151 offset:36864
    ds_read_b64_tr_b16 a[160:161], v144 offset:40960
    ds_read_b64_tr_b16 a[162:163], v145 offset:40960
    ds_read_b64_tr_b16 a[164:165], v146 offset:40960
    ds_read_b64_tr_b16 a[166:167], v147 offset:40960
    ds_read_b64_tr_b16 a[168:169], v148 offset:40960
    ds_read_b64_tr_b16 a[170:171], v149 offset:40960
    ds_read_b64_tr_b16 a[172:173], v150 offset:40960
    buffer_load_dwordx4 v3, s[52:55], s65 offen offset:0 nt lds
    ds_read_b64_tr_b16 a[174:175], v151 offset:40960
    ds_read_b64_tr_b16 a[176:177], v144 offset:45056
    ds_read_b64_tr_b16 a[178:179], v145 offset:45056
    ds_read_b64_tr_b16 a[180:181], v146 offset:45056
    ds_read_b64_tr_b16 a[182:183], v147 offset:45056
    ds_read_b64_tr_b16 a[184:185], v148 offset:45056
    ds_read_b64_tr_b16 a[186:187], v149 offset:45056
    ds_read_b64_tr_b16 a[188:189], v150 offset:45056
    ds_read_b64_tr_b16 a[190:191], v151 offset:45056
    ds_read_b64_tr_b16 a[192:193], v144 offset:49152
    ds_read_b64_tr_b16 a[194:195], v145 offset:49152
    ds_read_b64_tr_b16 a[196:197], v146 offset:49152
    ds_read_b64_tr_b16 a[198:199], v147 offset:49152
    ds_read_b64_tr_b16 a[200:201], v148 offset:49152
    ds_read_b64_tr_b16 a[202:203], v149 offset:49152
    ds_read_b64_tr_b16 a[204:205], v150 offset:49152
    buffer_load_dwordx4 v3, s[52:55], s65 offen offset:1024 nt lds
    ds_read_b64_tr_b16 a[206:207], v151 offset:49152
    ds_read_b64_tr_b16 a[208:209], v144 offset:53248
    ds_read_b64_tr_b16 a[210:211], v145 offset:53248
    ds_read_b64_tr_b16 a[212:213], v146 offset:53248
    ds_read_b64_tr_b16 a[214:215], v147 offset:53248
    ds_read_b64_tr_b16 a[216:217], v148 offset:53248
    ds_read_b64_tr_b16 a[218:219], v149 offset:53248
    ds_read_b64_tr_b16 a[220:221], v150 offset:53248
    ds_read_b64_tr_b16 a[222:223], v151 offset:53248
    ds_read_b64_tr_b16 a[224:225], v144 offset:57344
    ds_read_b64_tr_b16 a[226:227], v145 offset:57344
    ds_read_b64_tr_b16 a[228:229], v146 offset:57344
    ds_read_b64_tr_b16 a[230:231], v147 offset:57344
    ds_read_b64_tr_b16 a[232:233], v148 offset:57344
    ds_read_b64_tr_b16 a[234:235], v149 offset:57344
    ds_read_b64_tr_b16 a[236:237], v150 offset:57344
    buffer_load_dwordx4 v3, s[52:55], s65 offen offset:2048 nt lds
    ds_read_b64_tr_b16 a[238:239], v151 offset:57344
    ds_read_b64_tr_b16 a[240:241], v144 offset:61440
    ds_read_b64_tr_b16 a[242:243], v145 offset:61440
    ds_read_b64_tr_b16 a[244:245], v146 offset:61440
    ds_read_b64_tr_b16 a[246:247], v147 offset:61440
    ds_read_b64_tr_b16 a[248:249], v148 offset:61440
    ds_read_b64_tr_b16 a[250:251], v149 offset:61440
    ds_read_b64_tr_b16 a[252:253], v150 offset:61440
    ds_read_b64_tr_b16 a[254:255], v151 offset:61440
    ds_read_b64_tr_b16 v[192:193], v144 offset:0
    ds_read_b64_tr_b16 v[194:195], v145 offset:0
    ds_read_b64_tr_b16 v[196:197], v146 offset:0
    ds_read_b64_tr_b16 v[198:199], v147 offset:0
    ds_read_b64_tr_b16 v[200:201], v148 offset:0
    ds_read_b64_tr_b16 v[202:203], v149 offset:0
    ds_read_b64_tr_b16 v[204:205], v150 offset:0
    buffer_load_dwordx4 v3, s[52:55], s65 offen offset:3072 nt lds
    ds_read_b64_tr_b16 v[206:207], v151 offset:0
    ds_read_b64_tr_b16 v[208:209], v144 offset:4096
    ds_read_b64_tr_b16 v[210:211], v145 offset:4096
    ds_read_b64_tr_b16 v[212:213], v146 offset:4096
    ds_read_b64_tr_b16 v[214:215], v147 offset:4096
    ds_read_b64_tr_b16 v[216:217], v148 offset:4096
    ds_read_b64_tr_b16 v[218:219], v149 offset:4096
    ds_read_b64_tr_b16 v[220:221], v150 offset:4096
    ds_read_b64_tr_b16 v[222:223], v151 offset:4096
    s_waitcnt vmcnt(4)
    s_mov_b64 exec, 1
    v_mov_b32 v2, 2
    buffer_store_dword v2, off, s[8:11], s83 sc1
    s_mov_b64 exec, -1
    v_cmp_gt_u32 vcc, 1, v15
    s_cbranch_vccnz chk_4_slow
chk_4_ok:
    s_xor_b32 s14, s91, 0
    buffer_load_dwordx4 v[48:51], v3, s[8:11], s14 offen offset:0 sc1
    v_mov_b32 v19, 0
    v_mov_b32_e64 v21, 0
    v_dot2c_f32_bf16 v19, v120, v136
    v_dot2c_f32_bf16 v19, v121, v137
    v_dot2c_f32_bf16 v19, v122, v138
    v_dot2c_f32_bf16 v19, v123, v139
    v_dot2c_f32_bf16 v19, v124, v140
    v_dot2c_f32_bf16 v19, v125, v141
    v_dot2c_f32_bf16 v19, v126, v142
    v_dot2c_f32_bf16 v19, v127, v143
    s_lshl_b32 s7, s90, 12
    s_add_u32 s7, s7, 5242880
    s_xor_b32 s15, s91, 8192
    buffer_load_dwordx4 v[80:83], v3, s[8:11], s15 offen offset:0 sc1
    s_lshr_b32 s64, s61, 3
    s_lshl_b32 s64, s64, 7
    s_lshl_b32 s12, s60, 9
    s_add_u32 s12, s12, s64
    v_lshlrev_b32 v6, 6, v10
    v_add_u32 v6, v6, v23
    v_lshlrev_b32 v7, 3, v11
    v_sub_u32 v6, v6, v7
    s_add_u32 s64, s5, 32
    v_add_u32 v14, s64, v6
    s_mul_i32 s13, s3, 458752
    s_add_u32 s13, s13, s74
    v_mov_b32 v112, 0
    v_mov_b32 v113, 0
    buffer_load_dwordx4 v[52:55], v3, s[8:11], s14 offen offset:1024 sc1
    v_lshl_add_u32 v6, v0, 3, s6
    v_add_u32 v7, s5, v23
    ds_write_b64 v6, v[112:113]
    ds_write_b64 v7, v[112:113]
    s_lshr_b32 s64, s3, 1
    s_mul_i32 s65, s64, 6912
    s_add_u32 s65, s65, 148992
    v_mov_b32 v26, s65
    ds_write2st64_b32 v26, v112, v112 offset0:0 offset1:9
    ds_write_b32 v26, v112 offset:4608
    v_lshl_add_u32 v6, v9, 2, v10
    v_lshl_add_u32 v15, v6, 2, s65
    v_lshrrev_b32 v6, 2, v9
    v_lshlrev_b32 v6, 7, v6
    v_lshl_add_u32 v6, v10, 5, v6
    v_add_u32 v17, v6, v23
    buffer_load_dwordx4 v[84:87], v3, s[8:11], s15 offen offset:1024 sc1
    s_lshl_b32 s67, s61, 16
    s_add_u32 s67, s67, 3145728
    s_lshl_b32 s64, s64, 15
    s_and_b32 s65, s3, 1
    s_lshl_b32 s66, s65, 8
    s_add_u32 s64, s64, s66
    s_lshl_b32 s66, s60, 12
    s_add_u32 s64, s64, s66
    s_add_u32 s16, s64, s67
    s_lshl_b32 s17, s3, 13
    s_add_u32 s17, s17, s67
    s_lshl_b32 s18, s61, 13
    s_add_u32 s18, s18, 262144
    s_add_u32 s19, s18, 4096
    s_lshl_b32 s64, s60, 10
    s_lshl_b32 s66, s3, 8
    s_add_u32 s64, s64, s66
    s_add_u32 s20, s64, s18
    s_xor_b32 s14, s91, 2048
    buffer_load_dwordx4 v[56:59], v3, s[8:11], s14 offen offset:0 sc1
    s_lshl_b32 s21, s90, 12
    s_add_u32 s21, s21, 7340032
    v_lshlrev_b32 v6, 9, v10
    v_lshl_add_u32 v25, v9, 4, v6
    v_lshrrev_b32 v7, 5, v0
    v_and_b32 v8, 1, v10
    v_lshlrev_b32 v6, 10, v7
    v_lshl_add_u32 v6, v8, 8, v6
    v_lshl_add_u32 v22, v9, 3, v6
    v_lshlrev_b32 v6, 2, v7
    v_lshl_add_u32 v6, v9, 3, v6
    s_xor_b32 s15, s91, 10240
    buffer_load_dwordx4 v[88:91], v3, s[8:11], s15 offen offset:0 sc1
    v_lshlrev_b32 v7, 6, v7
    v_lshl_add_u32 v7, v9, 2, v7
    v_add_u32 v7, 128, v7
    v_cmp_eq_u32 vcc, 0, v8
    s_nop 1
    v_cndmask_b32 v24, v7, v6, vcc
    s_mul_i32 s23, s61, 229376
    s_add_u32 s23, s23, 9437184
    s_lshl_b32 s24, s94, 12
    s_add_u32 s24, s24, s23
    s_add_u32 s24, s24, s97
    s_lshr_b32 s64, s61, 2
    s_lshr_b32 s65, 0x3b, s64
    s_and_b32 s65, s65, 1
    s_lshl_b32 s65, s65, 7
    buffer_load_dwordx4 v[60:63], v3, s[8:11], s14 offen offset:1024 sc1
    s_lshl_b32 s64, s3, 15
    s_add_u32 s65, s65, s64
    s_lshl_b32 s64, s60, 9
    s_add_u32 s25, s65, s64
    v_mov_b32 v18, 0
    v_mov_b32 v20, 0
    v_lshlrev_b32 v28, 10, v13
    buffer_load_dwordx4 v[92:95], v3, s[8:11], s15 offen offset:1024 sc1
    s_xor_b32 s14, s91, 4096
    buffer_load_dwordx4 v[64:67], v3, s[8:11], s14 offen offset:0 sc1
    s_waitcnt vmcnt(8) lgkmcnt(12)
    v_mfma_f32_16x16x32_bf16 v[240:243], v[192:195], v[48:51], 0
    v_mfma_f32_16x16x32_bf16 v[244:247], v[196:199], v[48:51], 0
    ds_read_b64_tr_b16 v[224:225], v144 offset:8192
    ds_read_b64_tr_b16 v[226:227], v145 offset:8192
    v_mfma_f32_16x16x32_bf16 v[248:251], v[200:203], v[48:51], 0
    v_mfma_f32_16x16x32_bf16 v[252:255], v[204:207], v[48:51], 0
    ds_read_b64_tr_b16 v[228:229], v146 offset:8192
    ds_read_b64_tr_b16 v[230:231], v147 offset:8192
    s_xor_b32 s15, s91, 12288
    buffer_load_dwordx4 v[96:99], v3, s[8:11], s15 offen offset:0 sc1
    s_waitcnt vmcnt(8)
    v_mfma_f32_16x16x32_bf16 v[240:243], a[128:131], v[80:83], v[240:243]
    v_mfma_f32_16x16x32_bf16 v[244:247], a[132:135], v[80:83], v[244:247]
    ds_read_b64_tr_b16 v[232:233], v148 offset:8192
    ds_read_b64_tr_b16 v[234:235], v149 offset:8192
    v_mfma_f32_16x16x32_bf16 v[248:251], a[136:139], v[80:83], v[248:251]
    v_mfma_f32_16x16x32_bf16 v[252:255], a[140:143], v[80:83], v[252:255]
    ds_read_b64_tr_b16 v[236:237], v150 offset:8192
    ds_read_b64_tr_b16 v[238:239], v151 offset:8192
    buffer_load_dwordx4 v[68:71], v3, s[8:11], s14 offen offset:1024 sc1
    s_waitcnt vmcnt(8) lgkmcnt(12)
    v_mfma_f32_16x16x32_bf16 v[240:243], v[208:211], v[52:55], v[240:243]
    v_mfma_f32_16x16x32_bf16 v[244:247], v[212:215], v[52:55], v[244:247]
    ds_read_b64_tr_b16 v[192:193], v144 offset:12288
    ds_read_b64_tr_b16 v[194:195], v145 offset:12288
    v_mfma_f32_16x16x32_bf16 v[248:251], v[216:219], v[52:55], v[248:251]
    v_mfma_f32_16x16x32_bf16 v[252:255], v[220:223], v[52:55], v[252:255]
    ds_read_b64_tr_b16 v[196:197], v146 offset:12288
    ds_read_b64_tr_b16 v[198:199], v147 offset:12288
    buffer_load_dwordx4 v[100:103], v3, s[8:11], s15 offen offset:1024 sc1
    s_waitcnt vmcnt(8)
    v_mfma_f32_16x16x32_bf16 v[240:243], a[144:147], v[84:87], v[240:243]
    v_mfma_f32_16x16x32_bf16 v[244:247], a[148:151], v[84:87], v[244:247]
    ds_read_b64_tr_b16 v[200:201], v148 offset:12288
    ds_read_b64_tr_b16 v[202:203], v149 offset:12288
    v_mfma_f32_16x16x32_bf16 v[248:251], a[152:155], v[84:87], v[248:251]
    v_mfma_f32_16x16x32_bf16 v[252:255], a[156:159], v[84:87], v[252:255]
    ds_read_b64_tr_b16 v[204:205], v150 offset:12288
    ds_read_b64_tr_b16 v[206:207], v151 offset:12288
    s_xor_b32 s14, s91, 6144
    buffer_load_dwordx4 v[72:75], v3, s[8:11], s14 offen offset:0 sc1
    s_waitcnt vmcnt(8) lgkmcnt(8)
    v_mfma_f32_16x16x32_bf16 v[240:243], v[224:227], v[56:59], v[240:243]
    v_mfma_f32_16x16x32_bf16 v[244:247], v[228:231], v[56:59], v[244:247]
    ds_read_b64_tr_b16 v[208:209], v144 offset:16384
    ds_read_b64_tr_b16 v[210:211], v145 offset:16384
    v_mfma_f32_16x16x32_bf16 v[248:251], v[232:235], v[56:59], v[248:251]
    v_mfma_f32_16x16x32_bf16 v[252:255], v[236:239], v[56:59], v[252:255]
    ds_read_b64_tr_b16 v[212:213], v146 offset:16384
    ds_read_b64_tr_b16 v[214:215], v147 offset:16384
    s_xor_b32 s15, s91, 14336
    buffer_load_dwordx4 v[104:107], v3, s[8:11], s15 offen offset:0 sc1
    s_waitcnt vmcnt(8)
    v_mfma_f32_16x16x32_bf16 v[240:243], a[160:163], v[88:91], v[240:243]
    v_mfma_f32_16x16x32_bf16 v[244:247], a[164:167], v[88:91], v[244:247]
    ds_read_b64_tr_b16 v[216:217], v148 offset:16384
    ds_read_b64_tr_b16 v[218:219], v149 offset:16384
    v_mfma_f32_16x16x32_bf16 v[248:251], a[168:171], v[88:91], v[248:251]
    v_mfma_f32_16x16x32_bf16 v[252:255], a[172:175], v[88:91], v[252:255]
    ds_read_b64_tr_b16 v[220:221], v150 offset:16384
    ds_read_b64_tr_b16 v[222:223], v151 offset:16384
    buffer_load_dwordx4 v[76:79], v3, s[8:11], s14 offen offset:1024 sc1
    s_waitcnt vmcnt(8) lgkmcnt(8)
    v_mfma_f32_16x16x32_bf16 v[240:243], v[192:195], v[60:63], v[240:243]
    v_mfma_f32_16x16x32_bf16 v[244:247], v[196:199], v[60:63], v[244:247]
    ds_read_b64_tr_b16 v[224:225], v144 offset:20480
    ds_read_b64_tr_b16 v[226:227], v145 offset:20480
    v_mfma_f32_16x16x32_bf16 v[248:251], v[200:203], v[60:63], v[248:251]
    v_mfma_f32_16x16x32_bf16 v[252:255], v[204:207], v[60:63], v[252:255]
    ds_read_b64_tr_b16 v[228:229], v146 offset:20480
    ds_read_b64_tr_b16 v[230:231], v147 offset:20480
    buffer_load_dwordx4 v[108:111], v3, s[8:11], s15 offen offset:1024 sc1
    s_waitcnt vmcnt(8)
    v_mfma_f32_16x16x32_bf16 v[240:243], a[176:179], v[92:95], v[240:243]
    v_mfma_f32_16x16x32_bf16 v[244:247], a[180:183], v[92:95], v[244:247]
    ds_read_b64_tr_b16 v[232:233], v148 offset:20480
    ds_read_b64_tr_b16 v[234:235], v149 offset:20480
    v_mfma_f32_16x16x32_bf16 v[248:251], a[184:187], v[92:95], v[248:251]
    v_mfma_f32_16x16x32_bf16 v[252:255], a[188:191], v[92:95], v[252:255]
    ds_read_b64_tr_b16 v[236:237], v150 offset:20480
    ds_read_b64_tr_b16 v[238:239], v151 offset:20480
    s_add_u32 s99, s95, 229376
    s_add_u32 m0, s98, 8192
    s_nop 0
    buffer_load_dwordx4 v32, s[44:47], s99 offen offset:0  lds
    s_waitcnt vmcnt(8) lgkmcnt(8)
    v_mfma_f32_16x16x32_bf16 v[240:243], v[208:211], v[64:67], v[240:243]
    v_mfma_f32_16x16x32_bf16 v[244:247], v[212:215], v[64:67], v[244:247]
    ds_read_b64_tr_b16 v[192:193], v144 offset:24576
    ds_read_b64_tr_b16 v[194:195], v145 offset:24576
    v_mfma_f32_16x16x32_bf16 v[248:251], v[216:219], v[64:67], v[248:251]
    v_mfma_f32_16x16x32_bf16 v[252:255], v[220:223], v[64:67], v[252:255]
    ds_read_b64_tr_b16 v[196:197], v146 offset:24576
    ds_read_b64_tr_b16 v[198:199], v147 offset:24576
    buffer_load_dwordx4 v33, s[44:47], s99 offen offset:1024  lds
    s_waitcnt vmcnt(8)
    v_mfma_f32_16x16x32_bf16 v[240:243], a[192:195], v[96:99], v[240:243]
    v_mfma_f32_16x16x32_bf16 v[244:247], a[196:199], v[96:99], v[244:247]
    ds_read_b64_tr_b16 v[200:201], v148 offset:24576
    ds_read_b64_tr_b16 v[202:203], v149 offset:24576
    v_mfma_f32_16x16x32_bf16 v[248:251], a[200:203], v[96:99], v[248:251]
    v_mfma_f32_16x16x32_bf16 v[252:255], a[204:207], v[96:99], v[252:255]
    ds_read_b64_tr_b16 v[204:205], v150 offset:24576
    ds_read_b64_tr_b16 v[206:207], v151 offset:24576
    buffer_load_dwordx4 v34, s[44:47], s99 offen offset:2048  lds
    s_waitcnt vmcnt(8) lgkmcnt(8)
    v_mfma_f32_16x16x32_bf16 v[240:243], v[224:227], v[68:71], v[240:243]
    v_mfma_f32_16x16x32_bf16 v[244:247], v[228:231], v[68:71], v[244:247]
    ds_read_b64_tr_b16 v[208:209], v144 offset:28672
    ds_read_b64_tr_b16 v[210:211], v145 offset:28672
    v_mfma_f32_16x16x32_bf16 v[248:251], v[232:235], v[68:71], v[248:251]
    v_mfma_f32_16x16x32_bf16 v[252:255], v[236:239], v[68:71], v[252:255]
    ds_read_b64_tr_b16 v[212:213], v146 offset:28672
    ds_read_b64_tr_b16 v[214:215], v147 offset:28672
    buffer_load_dwordx4 v35, s[44:47], s99 offen offset:3072  lds
    s_add_u32 s99, s95, 344064
    s_waitcnt vmcnt(8)
    v_mfma_f32_16x16x32_bf16 v[240:243], a[208:211], v[100:103], v[240:243]
    v_mfma_f32_16x16x32_bf16 v[244:247], a[212:215], v[100:103], v[244:247]
    ds_read_b64_tr_b16 v[216:217], v148 offset:28672
    ds_read_b64_tr_b16 v[218:219], v149 offset:28672
    v_mfma_f32_16x16x32_bf16 v[248:251], a[216:219], v[100:103], v[248:251]
    v_mfma_f32_16x16x32_bf16 v[252:255], a[220:223], v[100:103], v[252:255]
    ds_read_b64_tr_b16 v[220:221], v150 offset:28672
    ds_read_b64_tr_b16 v[222:223], v151 offset:28672
    buffer_load_dword v29, v28, s[8:11], s12 offen sc1
    s_add_u32 m0, s98, 12288
    s_nop 0
    buffer_load_dwordx4 v32, s[44:47], s99 offen offset:0  lds
    ds_read_b64_tr_b16 a[0:1], v36 offset:0
    s_waitcnt vmcnt(9) lgkmcnt(9)
    v_mfma_f32_16x16x32_bf16 v[240:243], v[192:195], v[72:75], v[240:243]
    v_mfma_f32_16x16x32_bf16 v[244:247], v[196:199], v[72:75], v[244:247]
    v_mfma_f32_16x16x32_bf16 v[248:251], v[200:203], v[72:75], v[248:251]
    v_mfma_f32_16x16x32_bf16 v[252:255], v[204:207], v[72:75], v[252:255]
    ds_read_b64_tr_b16 a[2:3], v36 offset:2048
    ds_read_b64_tr_b16 a[4:5], v37 offset:0
    s_waitcnt vmcnt(8)
    v_mfma_f32_16x16x32_bf16 v[240:243], a[224:227], v[104:107], v[240:243]
    v_mfma_f32_16x16x32_bf16 v[244:247], a[228:231], v[104:107], v[244:247]
    v_mfma_f32_16x16x32_bf16 v[248:251], a[232:235], v[104:107], v[248:251]
    v_mfma_f32_16x16x32_bf16 v[252:255], a[236:239], v[104:107], v[252:255]
    ds_read_b64_tr_b16 a[6:7], v37 offset:2048
    buffer_load_dwordx4 v33, s[44:47], s99 offen offset:1024  lds
    s_waitcnt vmcnt(8) lgkmcnt(4)
    v_mfma_f32_16x16x32_bf16 v[240:243], v[208:211], v[76:79], v[240:243]
    v_mfma_f32_16x16x32_bf16 v[244:247], v[212:215], v[76:79], v[244:247]
    v_mfma_f32_16x16x32_bf16 v[248:251], v[216:219], v[76:79], v[248:251]
    v_mfma_f32_16x16x32_bf16 v[252:255], v[220:223], v[76:79], v[252:255]
    ds_read_b64_tr_b16 a[8:9], v36 offset:1024
    ds_read_b64_tr_b16 a[10:11], v36 offset:3072
    s_waitcnt vmcnt(7)
    v_mfma_f32_16x16x32_bf16 v[240:243], a[240:243], v[108:111], v[240:243]
    v_mfma_f32_16x16x32_bf16 v[244:247], a[244:247], v[108:111], v[244:247]
    v_mfma_f32_16x16x32_bf16 v[248:251], a[248:251], v[108:111], v[248:251]
    v_mfma_f32_16x16x32_bf16 v[252:255], a[252:255], v[108:111], v[252:255]
    ds_read_b64_tr_b16 a[12:13], v37 offset:1024
    ds_read_b64_tr_b16 a[14:15], v37 offset:3072
    s_nop 2
    v_dot2_f32_bf16 v112, v120, s69, v240
    ds_read_b64_tr_b16 v[108:109], v14 offset:3872
    v_dot2_f32_bf16 v113, v120, s70, v241
    ds_read_b64_tr_b16 v[110:111], v14 offset:3840
    v_dot2_f32_bf16 v114, v121, s69, v242
    ds_read_b64_tr_b16 v[104:105], v14 offset:3616
    v_dot2_f32_bf16 v115, v121, s70, v243
    ds_read_b64_tr_b16 v[106:107], v14 offset:3584
    v_dot2_f32_bf16 v116, v122, s69, v244
    ds_read_b64_tr_b16 v[100:101], v14 offset:3360
    v_dot2_f32_bf16 v117, v122, s70, v245
    ds_read_b64_tr_b16 v[102:103], v14 offset:3328
    v_dot2_f32_bf16 v118, v123, s69, v246
    ds_read_b64_tr_b16 v[96:97], v14 offset:3104
    v_dot2_f32_bf16 v119, v123, s70, v247
    ds_read_b64_tr_b16 v[98:99], v14 offset:3072
    v_cvt_pk_bf16_f32 v128, v112, v113
    ds_read_b64_tr_b16 v[92:93], v14 offset:2848
    v_cvt_pk_bf16_f32 v129, v114, v115
    ds_read_b64_tr_b16 v[94:95], v14 offset:2816
    v_cvt_pk_bf16_f32 v130, v116, v117
    ds_read_b64_tr_b16 v[88:89], v14 offset:2592
    v_cvt_pk_bf16_f32 v131, v118, v119
    ds_read_b64_tr_b16 v[90:91], v14 offset:2560
    buffer_store_dwordx4 v[128:131], v25, s[8:11], s16 offen offset:0 sc1
    ds_read_b64_tr_b16 v[84:85], v14 offset:2336
    v_dot2_f32_bf16 v112, v124, s69, v248
    ds_read_b64_tr_b16 v[86:87], v14 offset:2304
    v_dot2_f32_bf16 v113, v124, s70, v249
    ds_read_b64_tr_b16 v[80:81], v14 offset:2080
    v_dot2_f32_bf16 v114, v125, s69, v250
    ds_read_b64_tr_b16 v[82:83], v14 offset:2048
    v_dot2_f32_bf16 v115, v125, s70, v251
    ds_read_b64_tr_b16 v[76:77], v14 offset:1824
    v_dot2_f32_bf16 v116, v126, s69, v252
    ds_read_b64_tr_b16 v[78:79], v14 offset:1792
    v_dot2_f32_bf16 v117, v126, s70, v253
    ds_read_b64_tr_b16 v[72:73], v14 offset:1568
    v_dot2_f32_bf16 v118, v127, s69, v254
    ds_read_b64_tr_b16 v[74:75], v14 offset:1536
    v_dot2_f32_bf16 v119, v127, s70, v255
    ds_read_b64_tr_b16 v[68:69], v14 offset:1312
    v_cvt_pk_bf16_f32 v132, v112, v113
    ds_read_b64_tr_b16 v[70:71], v14 offset:1280
    v_cvt_pk_bf16_f32 v133, v114, v115
    ds_read_b64_tr_b16 v[64:65], v14 offset:1056
    v_cvt_pk_bf16_f32 v134, v116, v117
    ds_read_b64_tr_b16 v[66:67], v14 offset:1024
    v_cvt_pk_bf16_f32 v135, v118, v119
    ds_read_b64_tr_b16 v[60:61], v14 offset:800
    buffer_store_dwordx4 v[132:135], v25, s[8:11], s16 offen offset:2048 sc1
    ds_read_b64_tr_b16 v[62:63], v14 offset:768
    s_waitcnt vmcnt(4)
    v_cmp_gt_u32 vcc, 2, v29
    s_cbranch_vccnz chk_6_slow
chk_6_ok:
    s_add_u32 m0, s6, 512
    s_nop 0
    buffer_load_dwordx4 v3, s[8:11], s7 offen offset:0 sc1  lds
    buffer_load_dwordx4 v3, s[8:11], s7 offen offset:1024 sc1  lds
    buffer_load_dwordx4 v3, s[8:11], s7 offen offset:2048 sc1  lds
    buffer_load_dwordx4 v3, s[8:11], s7 offen offset:3072 sc1  lds
    v_dot2c_f32_bf16 v18, s68, v128
    ds_read_b64_tr_b16 v[56:57], v14 offset:544
    v_dot2c_f32_bf16 v20, v128, v128
    ds_read_b64_tr_b16 v[58:59], v14 offset:512
    v_dot2c_f32_bf16 v18, s68, v129
    ds_read_b64_tr_b16 v[52:53], v14 offset:288
    v_dot2c_f32_bf16 v20, v129, v129
    ds_read_b64_tr_b16 v[54:55], v14 offset:256
    v_dot2c_f32_bf16 v18, s68, v130
    ds_read_b64_tr_b16 v[48:49], v14 offset:32
    v_dot2c_f32_bf16 v20, v130, v130
    ds_read_b64_tr_b16 v[50:51], v14 offset:0
    v_dot2c_f32_bf16 v18, s68, v131
    v_dot2c_f32_bf16 v20, v131, v131
    v_dot2c_f32_bf16 v18, s68, v132
    v_dot2c_f32_bf16 v20, v132, v132
    v_dot2c_f32_bf16 v18, s68, v133
    v_dot2c_f32_bf16 v20, v133, v133
    v_dot2c_f32_bf16 v18, s68, v134
    v_dot2c_f32_bf16 v20, v134, v134
    v_dot2c_f32_bf16 v18, s68, v135
    v_dot2c_f32_bf16 v20, v135, v135
    s_nop 2
    v_permlane32_swap_b32 v18, v20
    v_permlane32_swap_b32 v19, v21
    v_add_f32 v18, v18, v20
    v_add_f32 v19, v19, v21
    s_nop 1
    v_permlane16_swap_b32 v18, v19
    v_add_f32 v18, v18, v19
    buffer_store_dword v18, v24, s[8:11], s20 offen sc1
    v_mov_b32 v194, 0
    v_mov_b32 v195, 0
    v_mov_b32 v164, 0
    v_mov_b32 v165, 0
    v_mov_b32 v200, 0
    v_mov_b32 v201, 0
    v_mov_b32 v170, 0
    v_mov_b32 v171, 0
    v_mov_b32 v206, 0
    v_mov_b32 v207, 0
    v_mov_b32 v176, 0
    v_mov_b32 v177, 0
    v_mov_b32 v212, 0
    v_mov_b32 v213, 0
    v_mov_b32 v182, 0
    v_mov_b32 v183, 0
    v_mov_b32 v218, 0
    v_mov_b32 v219, 0
    v_mov_b32 v188, 0
    v_mov_b32 v189, 0
    v_lshlrev_b32 v6, 1, v10
    v_sub_u32 v6, v9, v6
    v_add_u32 v6, 7, v6
    v_lshrrev_b32 v7, 2, v6
    v_lshl_add_u32 v7, v7, 7, s6
    v_and_b32 v8, 3, v6
    v_lshl_add_u32 v7, v8, 3, v7
    v_lshrrev_b32 v6, 3, v6
    v_add_u32 v8, 0, v6
    v_and_b32 v8, 3, v8
    v_lshl_add_u32 v112, v8, 5, v7
    v_add_u32 v8, 1, v6
    v_and_b32 v8, 3, v8
    v_lshl_add_u32 v113, v8, 5, v7
    v_add_u32 v8, 2, v6
    v_and_b32 v8, 3, v8
    v_lshl_add_u32 v114, v8, 5, v7
    v_add_u32 v8, 3, v6
    v_and_b32 v8, 3, v8
    v_lshl_add_u32 v115, v8, 5, v7
    v_lshlrev_b32 v6, 1, v10
    v_sub_u32 v6, v9, v6
    v_add_u32 v6, 8, v6
    v_lshrrev_b32 v7, 2, v6
    v_lshl_add_u32 v7, v7, 7, s6
    v_and_b32 v8, 3, v6
    v_lshl_add_u32 v7, v8, 3, v7
    v_lshrrev_b32 v6, 3, v6
    v_add_u32 v8, 0, v6
    v_and_b32 v8, 3, v8
    v_lshl_add_u32 v116, v8, 5, v7
    v_add_u32 v8, 1, v6
    v_and_b32 v8, 3, v8
    v_lshl_add_u32 v117, v8, 5, v7
    v_add_u32 v8, 2, v6
    v_and_b32 v8, 3, v8
    v_lshl_add_u32 v118, v8, 5, v7
    v_add_u32 v8, 3, v6
    v_and_b32 v8, 3, v8
    v_lshl_add_u32 v119, v8, 5, v7
    v_lshrrev_b32 v7, 2, v9
    v_lshl_add_u32 v7, v7, 7, s6
    v_add_u32 v7, v7, v23
    v_lshl_add_u32 v7, v10, 1, v7
    v_add_u32 v7, 512, v7
    v_lshrrev_b32 v6, 3, v9
    v_add_u32 v8, 0, v6
    v_and_b32 v8, 3, v8
    v_lshl_add_u32 v28, v8, 5, v7
    v_add_u32 v8, 1, v6
    v_and_b32 v8, 3, v8
    v_lshl_add_u32 v29, v8, 5, v7
    v_add_u32 v8, 2, v6
    v_and_b32 v8, 3, v8
    v_lshl_add_u32 v30, v8, 5, v7
    v_add_u32 v8, 3, v6
    v_and_b32 v8, 3, v8
    v_lshl_add_u32 v31, v8, 5, v7
    s_add_u32 m0, s98, 12288
    s_nop 0
    buffer_load_dwordx4 v34, s[44:47], s99 offen offset:2048  lds
    buffer_load_dwordx4 v35, s[44:47], s99 offen offset:3072  lds
    s_add_u32 s99, s95, 458752
    s_waitcnt lgkmcnt(15)
    s_add_u32 m0, s98, 0
    s_nop 0
    buffer_load_dwordx4 v32, s[44:47], s99 offen offset:0  lds
    ds_read_b64_tr_b16 a[16:17], v36 offset:4096
    ds_read_b64_tr_b16 a[18:19], v36 offset:6144
    ds_read_b64_tr_b16 a[20:21], v37 offset:4096
    ds_read_b64_tr_b16 a[22:23], v37 offset:6144
    buffer_load_dwordx4 v33, s[44:47], s99 offen offset:1024  lds
    ds_read_b64_tr_b16 a[24:25], v36 offset:5120
    ds_read_b64_tr_b16 a[26:27], v36 offset:7168
    ds_read_b64_tr_b16 a[28:29], v37 offset:5120
    ds_read_b64_tr_b16 a[30:31], v37 offset:7168
    buffer_load_dwordx4 v34, s[44:47], s99 offen offset:2048  lds
    buffer_load_dwordx4 v35, s[44:47], s99 offen offset:3072  lds
    s_bitcmp1_b32 s3, 0
    s_cbranch_scc1 odd_8
    s_waitcnt vmcnt(7)
    ds_read_b64 v[240:241], v114 offset:0
    ds_read_b64 v[242:243], v118 offset:0
    ds_read_b64 v[244:245], v115 offset:256
    ds_read_b64 v[246:247], v119 offset:256
    ds_read_b64 v[248:249], v112 offset:512
    ds_read_b64 v[250:251], v116 offset:512
    ds_read_b64 v[252:253], v113 offset:768
    ds_read_b64 v[254:255], v117 offset:768
    ds_read_b64 v[136:137], v114 offset:1024
    ds_read_b64 v[138:139], v118 offset:1024
    ds_read_b64 v[140:141], v115 offset:1280
    ds_read_b64 v[142:143], v119 offset:1280
    s_waitcnt lgkmcnt(8)
    v_mfma_f32_16x16x32_bf16 v[160:163], v[108:111], v[240:243], 0
    ds_read_b64 v[144:145], v112 offset:1536
    s_add_u32 s99, s95, 573440
    v_mfma_f32_16x16x32_bf16 v[166:169], v[100:103], v[240:243], 0
    ds_read_b64 v[146:147], v116 offset:1536
    s_add_u32 m0, s98, 4096
    s_nop 0
    buffer_load_dwordx4 v32, s[44:47], s99 offen offset:0  lds
    v_mfma_f32_16x16x32_bf16 v[172:175], v[68:71], v[240:243], 0
    ds_read_b64_tr_b16 a[32:33], v36 offset:8192
    ds_read_b64_tr_b16 a[34:35], v36 offset:10240
    v_mfma_f32_16x16x32_bf16 v[160:163], v[104:107], v[244:247], v[160:163]
    ds_read_b64 v[148:149], v113 offset:1792
    ds_read_b64_tr_b16 a[36:37], v37 offset:8192
    v_mfma_f32_16x16x32_bf16 v[166:169], v[96:99], v[244:247], v[166:169]
    ds_read_b64 v[150:151], v117 offset:1792
    ds_read_b64_tr_b16 a[38:39], v37 offset:10240
    v_mfma_f32_16x16x32_bf16 v[172:175], v[64:67], v[244:247], v[172:175]
    buffer_load_dwordx4 v33, s[44:47], s99 offen offset:1024  lds
    ds_read_b64_tr_b16 a[40:41], v36 offset:9216
    s_waitcnt lgkmcnt(13)
    v_mfma_f32_16x16x32_bf16 v[160:163], v[100:103], v[248:251], v[160:163]
    ds_read_b64 v[240:241], v114 offset:2048
    ds_read_b64_tr_b16 a[42:43], v36 offset:11264
    v_mfma_f32_16x16x32_bf16 v[166:169], v[92:95], v[248:251], v[166:169]
    ds_read_b64 v[242:243], v118 offset:2048
    ds_read_b64_tr_b16 a[44:45], v37 offset:9216
    v_mfma_f32_16x16x32_bf16 v[172:175], v[60:63], v[248:251], v[172:175]
    ds_read_b64_tr_b16 a[46:47], v37 offset:11264
    buffer_load_dwordx4 v34, s[44:47], s99 offen offset:2048  lds
    v_mfma_f32_16x16x32_bf16 v[160:163], v[96:99], v[252:255], v[160:163]
    ds_read_b64 v[244:245], v115 offset:2304
    v_mfma_f32_16x16x32_bf16 v[166:169], v[88:91], v[252:255], v[166:169]
    ds_read_b64 v[246:247], v119 offset:2304
    v_mfma_f32_16x16x32_bf16 v[172:175], v[56:59], v[252:255], v[172:175]
    buffer_load_dwordx4 v35, s[44:47], s99 offen offset:3072  lds
    s_add_u32 s99, s95, 688128
    s_waitcnt lgkmcnt(15)
    v_mfma_f32_16x16x32_bf16 v[160:163], v[92:95], v[136:139], v[160:163]
    ds_read_b64 v[248:249], v112 offset:2560
    v_mfma_f32_16x16x32_bf16 v[166:169], v[84:87], v[136:139], v[166:169]
    ds_read_b64 v[250:251], v116 offset:2560
    v_mfma_f32_16x16x32_bf16 v[172:175], v[52:55], v[136:139], v[172:175]
    s_waitcnt lgkmcnt(4)
    s_add_u32 m0, s98, 8192
    s_nop 0
    buffer_load_dwordx4 v32, s[44:47], s99 offen offset:0  lds
    v_mfma_f32_16x16x32_bf16 v[160:163], v[88:91], v[140:143], v[160:163]
    ds_read_b64 v[252:253], v113 offset:2816
    s_waitcnt vmcnt(9)
    ds_read_b64_tr_b16 a[48:49], v36 offset:12288
    v_mfma_f32_16x16x32_bf16 v[166:169], v[80:83], v[140:143], v[166:169]
    ds_read_b64 v[254:255], v117 offset:2816
    ds_read_b64_tr_b16 a[50:51], v36 offset:14336
    v_mfma_f32_16x16x32_bf16 v[172:175], v[48:51], v[140:143], v[172:175]
    ds_read_b64_tr_b16 a[52:53], v37 offset:12288
    ds_read_b64_tr_b16 a[54:55], v37 offset:14336
    v_mfma_f32_16x16x32_bf16 v[160:163], v[84:87], v[144:147], v[160:163]
    ds_read_b64 v[136:137], v114 offset:3072
    buffer_load_dwordx4 v33, s[44:47], s99 offen offset:1024  lds
    v_mfma_f32_16x16x32_bf16 v[166:169], v[76:79], v[144:147], v[166:169]
    ds_read_b64 v[138:139], v118 offset:3072
    ds_read_b64_tr_b16 a[56:57], v36 offset:13312
    v_mfma_f32_16x16x32_bf16 v[160:163], v[80:83], v[148:151], v[160:163]
    ds_read_b64 v[140:141], v115 offset:3328
    ds_read_b64_tr_b16 a[58:59], v36 offset:15360
    v_mfma_f32_16x16x32_bf16 v[166:169], v[72:75], v[148:151], v[166:169]
    ds_read_b64 v[142:143], v119 offset:3328
    ds_read_b64_tr_b16 a[60:61], v37 offset:13312
    s_waitcnt lgkmcnt(15)
    v_mfma_f32_16x16x32_bf16 v[160:163], v[76:79], v[240:243], v[160:163]
    ds_read_b64 v[144:145], v112 offset:3584
    ds_read_b64_tr_b16 a[62:63], v37 offset:15360
    v_mfma_f32_16x16x32_bf16 v[166:169], v[68:71], v[240:243], v[166:169]
    ds_read_b64 v[146:147], v116 offset:3584
    s_mov_b64 exec, 1
    v_mov_b32 v2, 3
    buffer_store_dword v2, off, s[8:11], s85
    buffer_store_dword v2, off, s[8:11], s83 sc1
    s_mov_b64 exec, -1
    buffer_load_dwordx4 v34, s[44:47], s99 offen offset:2048  lds
    v_mfma_f32_16x16x32_bf16 v[160:163], v[72:75], v[244:247], v[160:163]
    ds_read_b64 v[148:149], v113 offset:3840
    v_mfma_f32_16x16x32_bf16 v[166:169], v[64:67], v[244:247], v[166:169]
    ds_read_b64 v[150:151], v117 offset:3840
    s_waitcnt lgkmcnt(15)
    v_mfma_f32_16x16x32_bf16 v[160:163], v[68:71], v[248:251], v[160:163]
    ds_read_b64 v[240:241], v115 offset:0
    buffer_load_dwordx4 v35, s[44:47], s99 offen offset:3072  lds
    v_mfma_f32_16x16x32_bf16 v[166:169], v[60:63], v[248:251], v[166:169]
    ds_read_b64 v[242:243], v119 offset:0
    v_mfma_f32_16x16x32_bf16 v[160:163], v[64:67], v[252:255], v[160:163]
    ds_read_b64 v[244:245], v112 offset:256
    v_mfma_f32_16x16x32_bf16 v[166:169], v[56:59], v[252:255], v[166:169]
    ds_read_b64 v[246:247], v116 offset:256
    s_lshl_b32 s99, s2, 2
    s_add_u32 s99, s99, s3
    s_mul_i32 s99, s99, 1792
    v_min_u32 v2, 13, v0
    v_lshlrev_b32 v2, 7, v2
    buffer_load_dword v5, v2, s[48:51], s99 offen
    s_waitcnt lgkmcnt(10)
    v_mfma_f32_16x16x32_bf16 v[160:163], v[60:63], v[136:139], v[160:163]
    ds_read_b64 v[248:249], v113 offset:512
    s_add_u32 s99, s95, 802816
    v_mfma_f32_16x16x32_bf16 v[166:169], v[52:55], v[136:139], v[166:169]
    ds_read_b64 v[250:251], v117 offset:512
    v_mfma_f32_16x16x32_bf16 v[160:163], v[56:59], v[140:143], v[160:163]
    ds_read_b64 v[252:253], v114 offset:768
    s_waitcnt lgkmcnt(10)
    s_add_u32 m0, s98, 12288
    s_nop 0
    buffer_load_dwordx4 v32, s[44:47], s99 offen offset:0  lds
    v_mfma_f32_16x16x32_bf16 v[166:169], v[48:51], v[140:143], v[166:169]
    ds_read_b64 v[254:255], v118 offset:768
    s_waitcnt vmcnt(12)
    ds_read_b64_tr_b16 a[64:65], v36 offset:0
    s_waitcnt lgkmcnt(9)
    v_mfma_f32_16x16x32_bf16 v[160:163], v[52:55], v[144:147], v[160:163]
    ds_read_b64 v[136:137], v115 offset:1024
    ds_read_b64_tr_b16 a[66:67], v36 offset:2048
    ds_read_b64 v[138:139], v119 offset:1024
    v_mfma_f32_16x16x32_bf16 v[160:163], v[48:51], v[148:151], v[160:163]
    ds_read_b64 v[140:141], v112 offset:1280
    ds_read_b64_tr_b16 a[68:69], v37 offset:0
    ds_read_b64 v[142:143], v116 offset:1280
    s_waitcnt lgkmcnt(11)
    v_mfma_f32_16x16x32_bf16 v[190:193], v[108:111], v[240:243], 0
    ds_read_b64 v[144:145], v113 offset:1536
    ds_read_b64_tr_b16 a[70:71], v37 offset:2048
    v_mfma_f32_16x16x32_bf16 v[196:199], v[100:103], v[240:243], 0
    ds_read_b64 v[146:147], v117 offset:1536
    buffer_load_dwordx4 v33, s[44:47], s99 offen offset:1024  lds
    v_mfma_f32_16x16x32_bf16 v[202:205], v[68:71], v[240:243], 0
    ds_read_b64_tr_b16 a[72:73], v36 offset:1024
    ds_read_b64_tr_b16 a[74:75], v36 offset:3072
    v_mfma_f32_16x16x32_bf16 v[190:193], v[104:107], v[244:247], v[190:193]
    ds_read_b64 v[148:149], v114 offset:1792
    ds_read_b64_tr_b16 a[76:77], v37 offset:1024
    v_mfma_f32_16x16x32_bf16 v[196:199], v[96:99], v[244:247], v[196:199]
    ds_read_b64 v[150:151], v118 offset:1792
    ds_read_b64_tr_b16 a[78:79], v37 offset:3072
    v_mfma_f32_16x16x32_bf16 v[202:205], v[64:67], v[244:247], v[202:205]
    buffer_load_dwordx4 v34, s[44:47], s99 offen offset:2048  lds
    s_waitcnt lgkmcnt(15)
    v_mfma_f32_16x16x32_bf16 v[190:193], v[100:103], v[248:251], v[190:193]
    ds_read_b64 v[240:241], v115 offset:2048
    v_mfma_f32_16x16x32_bf16 v[196:199], v[92:95], v[248:251], v[196:199]
    ds_read_b64 v[242:243], v119 offset:2048
    v_mfma_f32_16x16x32_bf16 v[202:205], v[60:63], v[248:251], v[202:205]
    buffer_load_dwordx4 v35, s[44:47], s99 offen offset:3072  lds
    s_add_u32 s99, s95, 917504
    v_mfma_f32_16x16x32_bf16 v[190:193], v[96:99], v[252:255], v[190:193]
    ds_read_b64 v[244:245], v112 offset:2304
    v_mfma_f32_16x16x32_bf16 v[196:199], v[88:91], v[252:255], v[196:199]
    ds_read_b64 v[246:247], v116 offset:2304
    v_mfma_f32_16x16x32_bf16 v[202:205], v[56:59], v[252:255], v[202:205]
    s_waitcnt lgkmcnt(4)
    s_add_u32 m0, s98, 0
    s_nop 0
    buffer_load_dwordx4 v32, s[44:47], s99 offen offset:0  lds
    v_mfma_f32_16x16x32_bf16 v[190:193], v[92:95], v[136:139], v[190:193]
    ds_read_b64 v[248:249], v113 offset:2560
    s_waitcnt vmcnt(12)
    ds_read_b64_tr_b16 a[80:81], v36 offset:4096
    v_mfma_f32_16x16x32_bf16 v[196:199], v[84:87], v[136:139], v[196:199]
    ds_read_b64 v[250:251], v117 offset:2560
    ds_read_b64_tr_b16 a[82:83], v36 offset:6144
    v_mfma_f32_16x16x32_bf16 v[202:205], v[52:55], v[136:139], v[202:205]
    ds_read_b64_tr_b16 a[84:85], v37 offset:4096
    ds_read_b64_tr_b16 a[86:87], v37 offset:6144
    v_mfma_f32_16x16x32_bf16 v[190:193], v[88:91], v[140:143], v[190:193]
    ds_read_b64 v[252:253], v114 offset:2816
    buffer_load_dwordx4 v33, s[44:47], s99 offen offset:1024  lds
    v_mfma_f32_16x16x32_bf16 v[196:199], v[80:83], v[140:143], v[196:199]
    ds_read_b64 v[254:255], v118 offset:2816
    ds_read_b64_tr_b16 a[88:89], v36 offset:5120
    v_mfma_f32_16x16x32_bf16 v[202:205], v[48:51], v[140:143], v[202:205]
    ds_read_b64_tr_b16 a[90:91], v36 offset:7168
    ds_read_b64_tr_b16 a[92:93], v37 offset:5120
    v_mfma_f32_16x16x32_bf16 v[190:193], v[84:87], v[144:147], v[190:193]
    ds_read_b64 v[136:137], v115 offset:3072
    ds_read_b64_tr_b16 a[94:95], v37 offset:7168
    v_mfma_f32_16x16x32_bf16 v[196:199], v[76:79], v[144:147], v[196:199]
    ds_read_b64 v[138:139], v119 offset:3072
    buffer_load_dwordx4 v34, s[44:47], s99 offen offset:2048  lds
    v_mfma_f32_16x16x32_bf16 v[190:193], v[80:83], v[148:151], v[190:193]
    ds_read_b64 v[140:141], v112 offset:3328
    v_mfma_f32_16x16x32_bf16 v[196:199], v[72:75], v[148:151], v[196:199]
    ds_read_b64 v[142:143], v116 offset:3328
    s_waitcnt lgkmcnt(15)
    v_mfma_f32_16x16x32_bf16 v[190:193], v[76:79], v[240:243], v[190:193]
    ds_read_b64 v[144:145], v113 offset:3584
    buffer_load_dwordx4 v35, s[44:47], s99 offen offset:3072  lds
    v_mfma_f32_16x16x32_bf16 v[196:199], v[68:71], v[240:243], v[196:199]
    ds_read_b64 v[146:147], v117 offset:3584
    s_add_u32 s99, s95, 1032192
    v_mfma_f32_16x16x32_bf16 v[190:193], v[72:75], v[244:247], v[190:193]
    ds_read_b64 v[148:149], v114 offset:3840
    v_mfma_f32_16x16x32_bf16 v[196:199], v[64:67], v[244:247], v[196:199]
    ds_read_b64 v[150:151], v118 offset:3840
    s_waitcnt lgkmcnt(7)
    s_add_u32 m0, s98, 4096
    s_nop 0
    buffer_load_dwordx4 v32, s[44:47], s99 offen offset:0  lds
    v_mfma_f32_16x16x32_bf16 v[190:193], v[68:71], v[248:251], v[190:193]
    ds_read_b64 v[240:241], v112 offset:0
    s_waitcnt vmcnt(10)
    ds_read_b64_tr_b16 a[96:97], v36 offset:8192
    v_mfma_f32_16x16x32_bf16 v[196:199], v[60:63], v[248:251], v[196:199]
    ds_read_b64 v[242:243], v116 offset:0
    ds_read_b64_tr_b16 a[98:99], v36 offset:10240
    v_mfma_f32_16x16x32_bf16 v[190:193], v[64:67], v[252:255], v[190:193]
    ds_read_b64 v[244:245], v113 offset:256
    ds_read_b64_tr_b16 a[100:101], v37 offset:8192
    v_mfma_f32_16x16x32_bf16 v[196:199], v[56:59], v[252:255], v[196:199]
    ds_read_b64 v[246:247], v117 offset:256
    ds_read_b64_tr_b16 a[102:103], v37 offset:10240
    s_waitcnt lgkmcnt(12)
    v_mfma_f32_16x16x32_bf16 v[190:193], v[60:63], v[136:139], v[190:193]
    ds_read_b64 v[248:249], v114 offset:512
    buffer_load_dwordx4 v33, s[44:47], s99 offen offset:1024  lds
    v_mfma_f32_16x16x32_bf16 v[196:199], v[52:55], v[136:139], v[196:199]
    ds_read_b64 v[250:251], v118 offset:512
    ds_read_b64_tr_b16 a[104:105], v36 offset:9216
    v_mfma_f32_16x16x32_bf16 v[190:193], v[56:59], v[140:143], v[190:193]
    ds_read_b64 v[252:253], v115 offset:768
    ds_read_b64_tr_b16 a[106:107], v36 offset:11264
    v_mfma_f32_16x16x32_bf16 v[196:199], v[48:51], v[140:143], v[196:199]
    ds_read_b64 v[254:255], v119 offset:768
    ds_read_b64_tr_b16 a[108:109], v37 offset:9216
    s_waitcnt lgkmcnt(15)
    v_mfma_f32_16x16x32_bf16 v[190:193], v[52:55], v[144:147], v[190:193]
    ds_read_b64 v[136:137], v112 offset:1024
    ds_read_b64_tr_b16 a[110:111], v37 offset:11264
    ds_read_b64 v[138:139], v116 offset:1024
    v_mfma_f32_16x16x32_bf16 v[190:193], v[48:51], v[148:151], v[190:193]
    ds_read_b64 v[140:141], v113 offset:1280
    buffer_load_dwordx4 v34, s[44:47], s99 offen offset:2048  lds
    ds_read_b64 v[142:143], v117 offset:1280
    s_waitcnt lgkmcnt(13)
    v_mfma_f32_16x16x32_bf16 v[162:165], v[108:111], v[240:243], v[162:165]
    ds_read_b64 v[144:145], v114 offset:1536
    v_mfma_f32_16x16x32_bf16 v[168:171], v[100:103], v[240:243], v[168:171]
    ds_read_b64 v[146:147], v118 offset:1536
    v_mfma_f32_16x16x32_bf16 v[174:177], v[68:71], v[240:243], v[174:177]
    buffer_load_dwordx4 v35, s[44:47], s99 offen offset:3072  lds
    s_add_u32 s99, s95, 1146880
    v_mfma_f32_16x16x32_bf16 v[162:165], v[104:107], v[244:247], v[162:165]
    ds_read_b64 v[148:149], v115 offset:1792
    v_mfma_f32_16x16x32_bf16 v[168:171], v[96:99], v[244:247], v[168:171]
    ds_read_b64 v[150:151], v119 offset:1792
    v_mfma_f32_16x16x32_bf16 v[174:177], v[64:67], v[244:247], v[174:177]
    s_waitcnt lgkmcnt(7)
    s_add_u32 m0, s98, 8192
    s_nop 0
    buffer_load_dwordx4 v32, s[44:47], s99 offen offset:0  lds
    v_mfma_f32_16x16x32_bf16 v[162:165], v[100:103], v[248:251], v[162:165]
    ds_read_b64 v[240:241], v112 offset:2048
    s_waitcnt vmcnt(9)
    ds_read_b64_tr_b16 a[112:113], v36 offset:12288
    v_mfma_f32_16x16x32_bf16 v[168:171], v[92:95], v[248:251], v[168:171]
    ds_read_b64 v[242:243], v116 offset:2048
    ds_read_b64_tr_b16 a[114:115], v36 offset:14336
    v_mfma_f32_16x16x32_bf16 v[174:177], v[60:63], v[248:251], v[174:177]
    ds_read_b64_tr_b16 a[116:117], v37 offset:12288
    ds_read_b64_tr_b16 a[118:119], v37 offset:14336
    v_mfma_f32_16x16x32_bf16 v[162:165], v[96:99], v[252:255], v[162:165]
    ds_read_b64 v[244:245], v113 offset:2304
    buffer_load_dwordx4 v33, s[44:47], s99 offen offset:1024  lds
    v_mfma_f32_16x16x32_bf16 v[168:171], v[88:91], v[252:255], v[168:171]
    ds_read_b64 v[246:247], v117 offset:2304
    ds_read_b64_tr_b16 a[120:121], v36 offset:13312
    v_mfma_f32_16x16x32_bf16 v[174:177], v[56:59], v[252:255], v[174:177]
    ds_read_b64_tr_b16 a[122:123], v36 offset:15360
    ds_read_b64_tr_b16 a[124:125], v37 offset:13312
    s_waitcnt lgkmcnt(15)
    v_mfma_f32_16x16x32_bf16 v[162:165], v[92:95], v[136:139], v[162:165]
    ds_read_b64 v[248:249], v114 offset:2560
    ds_read_b64_tr_b16 a[126:127], v37 offset:15360
    v_mfma_f32_16x16x32_bf16 v[168:171], v[84:87], v[136:139], v[168:171]
    ds_read_b64 v[250:251], v118 offset:2560
    buffer_load_dwordx4 v34, s[44:47], s99 offen offset:2048  lds
    v_mfma_f32_16x16x32_bf16 v[174:177], v[52:55], v[136:139], v[174:177]
    v_mfma_f32_16x16x32_bf16 v[162:165], v[88:91], v[140:143], v[162:165]
    ds_read_b64 v[252:253], v115 offset:2816
    v_mfma_f32_16x16x32_bf16 v[168:171], v[80:83], v[140:143], v[168:171]
    ds_read_b64 v[254:255], v119 offset:2816
    buffer_load_dwordx4 v35, s[44:47], s99 offen offset:3072  lds
    v_mfma_f32_16x16x32_bf16 v[174:177], v[48:51], v[140:143], v[174:177]
    s_waitcnt lgkmcnt(15)
    v_mfma_f32_16x16x32_bf16 v[162:165], v[84:87], v[144:147], v[162:165]
    ds_read_b64 v[136:137], v112 offset:3072
    v_mfma_f32_16x16x32_bf16 v[168:171], v[76:79], v[144:147], v[168:171]
    ds_read_b64 v[138:139], v116 offset:3072
    s_lshr_b32 s99, s2, 3
    s_lshl_b32 s99, s99, 2
    s_add_u32 s99, s99, s3
    s_mul_i32 s99, s99, 14336
    v_min_u32 v2, 13, v0
    v_lshlrev_b32_e64 v2, 10, v2
    buffer_load_dword v5, v2, s[48:51], s99 offen offset:384
    v_mfma_f32_16x16x32_bf16 v[162:165], v[80:83], v[148:151], v[162:165]
    ds_read_b64 v[140:141], v113 offset:3328
    s_add_u32 s99, s95, 1261568
    v_mfma_f32_16x16x32_bf16 v[168:171], v[72:75], v[148:151], v[168:171]
    ds_read_b64 v[142:143], v117 offset:3328
    s_waitcnt lgkmcnt(12)
    v_mfma_f32_16x16x32_bf16 v[162:165], v[76:79], v[240:243], v[162:165]
    ds_read_b64 v[144:145], v114 offset:3584
    s_waitcnt lgkmcnt(8)
    s_add_u32 m0, s98, 12288
    s_nop 0
    buffer_load_dwordx4 v32, s[44:47], s99 offen offset:0  lds
    v_mfma_f32_16x16x32_bf16 v[168:171], v[68:71], v[240:243], v[168:171]
    ds_read_b64 v[146:147], v118 offset:3584
    s_waitcnt vmcnt(10)
    ds_read_b64_tr_b16 a[128:129], v36 offset:0
    v_mfma_f32_16x16x32_bf16 v[162:165], v[72:75], v[244:247], v[162:165]
    ds_read_b64 v[148:149], v115 offset:3840
    ds_read_b64_tr_b16 a[130:131], v36 offset:2048
    v_mfma_f32_16x16x32_bf16 v[168:171], v[64:67], v[244:247], v[168:171]
    ds_read_b64 v[150:151], v119 offset:3840
    ds_read_b64_tr_b16 a[132:133], v37 offset:0
    s_waitcnt lgkmcnt(11)
    v_mfma_f32_16x16x32_bf16 v[162:165], v[68:71], v[248:251], v[162:165]
    ds_read_b64 v[240:241], v113 offset:0
    ds_read_b64_tr_b16 a[134:135], v37 offset:2048
    v_mfma_f32_16x16x32_bf16 v[168:171], v[60:63], v[248:251], v[168:171]
    ds_read_b64 v[242:243], v117 offset:0
    buffer_load_dwordx4 v33, s[44:47], s99 offen offset:1024  lds
    v_mfma_f32_16x16x32_bf16 v[162:165], v[64:67], v[252:255], v[162:165]
    ds_read_b64 v[244:245], v114 offset:256
    ds_read_b64_tr_b16 a[136:137], v36 offset:1024
    v_mfma_f32_16x16x32_bf16 v[168:171], v[56:59], v[252:255], v[168:171]
    ds_read_b64 v[246:247], v118 offset:256
    ds_read_b64_tr_b16 a[138:139], v36 offset:3072
    s_waitcnt lgkmcnt(14)
    v_mfma_f32_16x16x32_bf16 v[162:165], v[60:63], v[136:139], v[162:165]
    ds_read_b64 v[248:249], v115 offset:512
    ds_read_b64_tr_b16 a[140:141], v37 offset:1024
    v_mfma_f32_16x16x32_bf16 v[168:171], v[52:55], v[136:139], v[168:171]
    ds_read_b64 v[250:251], v119 offset:512
    buffer_load_dword v24, v13, s[8:11], s84 offen sc1
    ds_read_b64_tr_b16 a[142:143], v37 offset:3072
    v_mfma_f32_16x16x32_bf16 v[162:165], v[56:59], v[140:143], v[162:165]
    ds_read_b64 v[252:253], v112 offset:768
    buffer_load_dwordx4 v34, s[44:47], s99 offen offset:2048  lds
    v_mfma_f32_16x16x32_bf16 v[168:171], v[48:51], v[140:143], v[168:171]
    ds_read_b64 v[254:255], v116 offset:768
    s_waitcnt lgkmcnt(14)
    v_mfma_f32_16x16x32_bf16 v[162:165], v[52:55], v[144:147], v[162:165]
    ds_read_b64 v[136:137], v113 offset:1024
    ds_read_b64 v[138:139], v117 offset:1024
    v_mfma_f32_16x16x32_bf16 v[162:165], v[48:51], v[148:151], v[162:165]
    ds_read_b64 v[140:141], v114 offset:1280
    buffer_load_dwordx4 v35, s[44:47], s99 offen offset:3072  lds
    ds_read_b64 v[142:143], v118 offset:1280
    s_waitcnt lgkmcnt(11)
    v_mfma_f32_16x16x32_bf16 v[192:195], v[108:111], v[240:243], v[192:195]
    ds_read_b64 v[144:145], v115 offset:1536
    s_add_u32 s99, s95, 1376256
    v_mfma_f32_16x16x32_bf16 v[198:201], v[100:103], v[240:243], v[198:201]
    ds_read_b64 v[146:147], v119 offset:1536
    v_mfma_f32_16x16x32_bf16 v[204:207], v[68:71], v[240:243], v[204:207]
    s_waitcnt lgkmcnt(8)
    s_add_u32 m0, s98, 0
    s_nop 0
    buffer_load_dwordx4 v32, s[44:47], s99 offen offset:0  lds
    v_mfma_f32_16x16x32_bf16 v[192:195], v[104:107], v[244:247], v[192:195]
    ds_read_b64 v[148:149], v112 offset:1792
    s_waitcnt vmcnt(11)
    ds_read_b64_tr_b16 a[144:145], v36 offset:4096
    v_mfma_f32_16x16x32_bf16 v[198:201], v[96:99], v[244:247], v[198:201]
    ds_read_b64 v[150:151], v116 offset:1792
    ds_read_u16_d16_hi v220, v30 offset:3584
    ds_read_b64_tr_b16 a[146:147], v36 offset:6144
    v_mfma_f32_16x16x32_bf16 v[204:207], v[64:67], v[244:247], v[204:207]
    ds_read_b64_tr_b16 a[148:149], v37 offset:4096
    ds_read_b64_tr_b16 a[150:151], v37 offset:6144
    s_waitcnt lgkmcnt(13)
    v_mfma_f32_16x16x32_bf16 v[192:195], v[100:103], v[248:251], v[192:195]
    ds_read_b64 v[240:241], v113 offset:2048
    ds_read_u16_d16_hi v221, v31 offset:3584
    buffer_load_dwordx4 v33, s[44:47], s99 offen offset:1024  lds
    v_mfma_f32_16x16x32_bf16 v[198:201], v[92:95], v[248:251], v[198:201]
    ds_read_b64 v[242:243], v117 offset:2048
    ds_read_b64_tr_b16 a[152:153], v36 offset:5120
    v_mfma_f32_16x16x32_bf16 v[204:207], v[60:63], v[248:251], v[204:207]
    ds_read_u16_d16_hi v222, v28 offset:3584
    ds_read_b64_tr_b16 a[154:155], v36 offset:7168
    v_mfma_f32_16x16x32_bf16 v[192:195], v[96:99], v[252:255], v[192:195]
    ds_read_b64 v[244:245], v114 offset:2304
    ds_read_b64_tr_b16 a[156:157], v37 offset:5120
    v_mfma_f32_16x16x32_bf16 v[198:201], v[88:91], v[252:255], v[198:201]
    ds_read_b64 v[246:247], v118 offset:2304
    ds_read_u16_d16_hi v223, v29 offset:3584
    ds_read_b64_tr_b16 a[158:159], v37 offset:7168
    v_mfma_f32_16x16x32_bf16 v[204:207], v[56:59], v[252:255], v[204:207]
    buffer_load_dwordx4 v34, s[44:47], s99 offen offset:2048  lds
    s_waitcnt lgkmcnt(15)
    v_mfma_f32_16x16x32_bf16 v[192:195], v[92:95], v[136:139], v[192:195]
    ds_read_b64 v[248:249], v115 offset:2560
    ds_read_u16_d16_hi v224, v28 offset:3072
    v_mfma_f32_16x16x32_bf16 v[198:201], v[84:87], v[136:139], v[198:201]
    ds_read_b64 v[250:251], v119 offset:2560
    v_mfma_f32_16x16x32_bf16 v[204:207], v[52:55], v[136:139], v[204:207]
    ds_read_u16_d16_hi v225, v29 offset:3072
    buffer_load_dwordx4 v35, s[44:47], s99 offen offset:3072  lds
    v_mfma_f32_16x16x32_bf16 v[192:195], v[88:91], v[140:143], v[192:195]
    ds_read_b64 v[252:253], v112 offset:2816
    s_add_u32 s99, s95, 1490944
    v_mfma_f32_16x16x32_bf16 v[198:201], v[80:83], v[140:143], v[198:201]
    ds_read_b64 v[254:255], v116 offset:2816
    ds_read_u16_d16_hi v226, v30 offset:3072
    v_mfma_f32_16x16x32_bf16 v[204:207], v[48:51], v[140:143], v[204:207]
    s_waitcnt vmcnt(6)
    v_cmp_gt_u32 vcc, 3, v24
    s_cbranch_vccnz chk_10_slow
chk_10_ok:
    s_waitcnt lgkmcnt(7)
    s_add_u32 m0, s98, 4096
    s_nop 0
    buffer_load_dwordx4 v32, s[44:47], s99 offen offset:0  lds
    v_mfma_f32_16x16x32_bf16 v[192:195], v[84:87], v[144:147], v[192:195]
    ds_read_b64 v[136:137], v113 offset:3072
    buffer_load_dwordx2 v[152:153], v22, s[8:11], s18 offen offset:0 sc1
    ds_read_u16_d16_hi v227, v31 offset:3072
    ds_read_b64_tr_b16 a[160:161], v36 offset:8192
    v_mfma_f32_16x16x32_bf16 v[198:201], v[76:79], v[144:147], v[198:201]
    ds_read_b64 v[138:139], v117 offset:3072
    ds_read_b64_tr_b16 a[162:163], v36 offset:10240
    v_mfma_f32_16x16x32_bf16 v[192:195], v[80:83], v[148:151], v[192:195]
    ds_read_b64 v[140:141], v114 offset:3328
    buffer_load_dwordx2 v[154:155], v22, s[8:11], s18 offen offset:2048 sc1
    ds_read_u16_d16_hi v228, v28 offset:1024
    ds_read_b64_tr_b16 a[164:165], v37 offset:8192
    v_mfma_f32_16x16x32_bf16 v[198:201], v[72:75], v[148:151], v[198:201]
    ds_read_b64 v[142:143], v118 offset:3328
    ds_read_b64_tr_b16 a[166:167], v37 offset:10240
    v_mfma_f32_16x16x32_bf16 v[192:195], v[76:79], v[240:243], v[192:195]
    ds_read_b64 v[144:145], v115 offset:3584
    buffer_load_dwordx2 v[156:157], v22, s[8:11], s19 offen offset:0 sc1
    ds_read_u16_d16_hi v229, v29 offset:1024
    buffer_load_dwordx4 v33, s[44:47], s99 offen offset:1024  lds
    v_mfma_f32_16x16x32_bf16 v[198:201], v[68:71], v[240:243], v[198:201]
    ds_read_b64 v[146:147], v119 offset:3584
    ds_read_b64_tr_b16 a[168:169], v36 offset:9216
    v_mfma_f32_16x16x32_bf16 v[192:195], v[72:75], v[244:247], v[192:195]
    ds_read_b64 v[148:149], v112 offset:3840
    buffer_load_dwordx2 v[158:159], v22, s[8:11], s19 offen offset:2048 sc1
    ds_read_u16_d16_hi v230, v30 offset:1024
    ds_read_b64_tr_b16 a[170:171], v36 offset:11264
    v_mfma_f32_16x16x32_bf16 v[198:201], v[64:67], v[244:247], v[198:201]
    ds_read_b64 v[150:151], v116 offset:3840
    ds_read_b64_tr_b16 a[172:173], v37 offset:9216
    s_waitcnt lgkmcnt(15)
    v_mfma_f32_16x16x32_bf16 v[192:195], v[68:71], v[248:251], v[192:195]
    ds_read_u16_d16_hi v231, v31 offset:1024
    ds_read_b64_tr_b16 a[174:175], v37 offset:11264
    v_mfma_f32_16x16x32_bf16 v[198:201], v[60:63], v[248:251], v[198:201]
    buffer_load_dwordx4 v34, s[44:47], s99 offen offset:2048  lds
    v_mfma_f32_16x16x32_bf16 v[192:195], v[64:67], v[252:255], v[192:195]
    v_mfma_f32_16x16x32_bf16 v[198:201], v[56:59], v[252:255], v[198:201]
    s_waitcnt lgkmcnt(12)
    v_mfma_f32_16x16x32_bf16 v[192:195], v[60:63], v[136:139], v[192:195]
    buffer_load_dwordx4 v35, s[44:47], s99 offen offset:3072  lds
    s_add_u32 s99, s95, 1605632
    v_mfma_f32_16x16x32_bf16 v[198:201], v[52:55], v[136:139], v[198:201]
    v_mfma_f32_16x16x32_bf16 v[192:195], v[56:59], v[140:143], v[192:195]
    v_mfma_f32_16x16x32_bf16 v[198:201], v[48:51], v[140:143], v[198:201]
    s_waitcnt lgkmcnt(0)
    s_add_u32 m0, s98, 8192
    s_nop 0
    buffer_load_dwordx4 v32, s[44:47], s99 offen offset:0  lds
    v_mfma_f32_16x16x32_bf16 v[192:195], v[52:55], v[144:147], v[192:195]
    s_waitcnt vmcnt(13)
    ds_read_b64_tr_b16 a[176:177], v36 offset:12288
    v_mfma_f32_16x16x32_bf16 v[192:195], v[48:51], v[148:151], v[192:195]
    ds_read_b64_tr_b16 a[178:179], v36 offset:14336
    ds_read_b64_tr_b16 a[180:181], v37 offset:12288
    ds_read_b64_tr_b16 a[182:183], v37 offset:14336
    buffer_load_dwordx4 v33, s[44:47], s99 offen offset:1024  lds
    ds_read_b64_tr_b16 a[184:185], v36 offset:13312
    ds_read_b64_tr_b16 a[186:187], v36 offset:15360
    ds_read_b64_tr_b16 a[188:189], v37 offset:13312
    ds_read_b64_tr_b16 a[190:191], v37 offset:15360
    buffer_load_dwordx4 v34, s[44:47], s99 offen offset:2048  lds
    buffer_load_dwordx4 v35, s[44:47], s99 offen offset:3072  lds
    s_xor_b32 s22, s17, 6144
    buffer_load_dwordx4 v[108:111], v3, s[8:11], s22 offen offset:1024 sc1
    v_add_u32 v26, 4, v15
    v_add_f32 v164, v164, v193
    v_add_f32 v165, v165, v194
    ds_write2st64_b32 v26, v164, v165 offset0:7 offset1:16
    ds_write_b32 v26, v195 offset:6400
    v_add_f32 v170, v170, v199
    v_add_f32 v171, v171, v200
    ds_write2st64_b32 v26, v170, v171 offset0:6 offset1:15
    ds_write_b32 v26, v201 offset:6144
    v_add_f32 v176, v176, v205
    v_add_f32 v177, v177, v206
    ds_write2st64_b32 v26, v176, v177 offset0:2 offset1:11
    ds_write_b32 v26, v207 offset:5120
    v_add_f32 v161, v161, v190
    v_add_f32 v162, v162, v191
    v_add_f32 v163, v163, v192
    v_add_f32 v167, v167, v196
    v_add_f32 v168, v168, v197
    v_add_f32 v169, v169, v198
    v_add_f32 v173, v173, v202
    v_add_f32 v174, v174, v203
    v_add_f32 v175, v175, v204
    s_waitcnt lgkmcnt(0)
    buffer_load_dwordx4 v[104:107], v3, s[8:11], s22 offen offset:0 sc1
    s_barrier
    ds_read2st64_b32 v[190:191], v15 offset0:7 offset1:16
    ds_read_b32 v192, v15 offset:6400
    ds_read2st64_b32 v[196:197], v15 offset0:6 offset1:15
    ds_read_b32 v198, v15 offset:6144
    ds_read2st64_b32 v[202:203], v15 offset0:2 offset1:11
    ds_read_b32 v204, v15 offset:5120
    v_fmac_f32 v160, v16, v220
    v_fmac_f32 v161, v16, v221
    v_fmac_f32 v162, v16, v222
    s_xor_b32 s22, s17, 4096
    buffer_load_dwordx4 v[100:103], v3, s[8:11], s22 offen offset:1024 sc1
    v_fmac_f32 v163, v16, v223
    v_fmac_f32 v166, v16, v224
    v_fmac_f32 v167, v16, v225
    v_fmac_f32 v168, v16, v226
    v_fmac_f32 v169, v16, v227
    v_fmac_f32 v172, v16, v228
    v_fmac_f32 v173, v16, v229
    v_fmac_f32 v174, v16, v230
    v_fmac_f32 v175, v16, v231
    s_waitcnt lgkmcnt(4)
    v_add_f32 v160, v160, v190
    v_add_f32 v161, v161, v191
    v_add_f32 v162, v162, v192
    v_cvt_pk_bf16_f32 v160, v160, v161
    v_cvt_pk_bf16_f32 v161, v162, v163
    buffer_load_dwordx4 v[96:99], v3, s[8:11], s22 offen offset:0 sc1
    s_waitcnt lgkmcnt(2)
    v_add_f32 v166, v166, v196
    v_add_f32 v167, v167, v197
    v_add_f32 v168, v168, v198
    v_cvt_pk_bf16_f32 v166, v166, v167
    v_cvt_pk_bf16_f32 v167, v168, v169
    s_waitcnt lgkmcnt(0)
    v_add_f32 v172, v172, v202
    v_add_f32 v173, v173, v203
    v_add_f32 v174, v174, v204
    v_cvt_pk_bf16_f32 v172, v172, v173
    v_cvt_pk_bf16_f32 v173, v174, v175
    s_xor_b32 s22, s17, 2048
    buffer_load_dwordx4 v[92:95], v3, s[8:11], s22 offen offset:1024 sc1
    buffer_load_dwordx4 v[88:91], v3, s[8:11], s22 offen offset:0 sc1
    s_xor_b32 s22, s17, 0
    buffer_load_dwordx4 v[84:87], v3, s[8:11], s22 offen offset:1024 sc1
    buffer_load_dwordx4 v[80:83], v3, s[8:11], s22 offen offset:0 sc1
    buffer_store_dwordx2 v[160:161], v17, s[8:11], s21 offen offset:3584 sc1
    buffer_store_dwordx2 v[166:167], v17, s[8:11], s21 offen offset:3072 sc1
    buffer_store_dwordx2 v[172:173], v17, s[8:11], s21 offen offset:1024 sc1
    s_branch join_9
odd_8:
    s_waitcnt vmcnt(7)
    ds_read_b64 v[240:241], v114 offset:0
    ds_read_b64 v[242:243], v118 offset:0
    ds_read_b64 v[244:245], v115 offset:256
    ds_read_b64 v[246:247], v119 offset:256
    ds_read_b64 v[248:249], v112 offset:512
    ds_read_b64 v[250:251], v116 offset:512
    ds_read_b64 v[252:253], v113 offset:768
    ds_read_b64 v[254:255], v117 offset:768
    ds_read_b64 v[136:137], v114 offset:1024
    ds_read_b64 v[138:139], v118 offset:1024
    ds_read_b64 v[140:141], v115 offset:1280
    ds_read_b64 v[142:143], v119 offset:1280
    s_waitcnt lgkmcnt(8)
    v_mfma_f32_16x16x32_bf16 v[160:163], v[92:95], v[240:243], 0
    ds_read_b64 v[144:145], v112 offset:1536
    s_add_u32 s99, s95, 573440
    v_mfma_f32_16x16x32_bf16 v[166:169], v[84:87], v[240:243], 0
    ds_read_b64 v[146:147], v116 offset:1536
    s_add_u32 m0, s98, 4096
    s_nop 0
    buffer_load_dwordx4 v32, s[44:47], s99 offen offset:0  lds
    v_mfma_f32_16x16x32_bf16 v[172:175], v[76:79], v[240:243], 0
    ds_read_b64_tr_b16 a[32:33], v36 offset:8192
    ds_read_b64_tr_b16 a[34:35], v36 offset:10240
    v_mfma_f32_16x16x32_bf16 v[178:181], v[60:63], v[240:243], 0
    ds_read_b64_tr_b16 a[36:37], v37 offset:8192
    ds_read_b64_tr_b16 a[38:39], v37 offset:10240
    v_mfma_f32_16x16x32_bf16 v[184:187], v[52:55], v[240:243], 0
    buffer_load_dwordx4 v33, s[44:47], s99 offen offset:1024  lds
    ds_read_b64_tr_b16 a[40:41], v36 offset:9216
    v_mfma_f32_16x16x32_bf16 v[160:163], v[88:91], v[244:247], v[160:163]
    ds_read_b64 v[148:149], v113 offset:1792
    ds_read_b64_tr_b16 a[42:43], v36 offset:11264
    v_mfma_f32_16x16x32_bf16 v[166:169], v[80:83], v[244:247], v[166:169]
    ds_read_b64 v[150:151], v117 offset:1792
    ds_read_b64_tr_b16 a[44:45], v37 offset:9216
    v_mfma_f32_16x16x32_bf16 v[172:175], v[72:75], v[244:247], v[172:175]
    ds_read_b64_tr_b16 a[46:47], v37 offset:11264
    buffer_load_dwordx4 v34, s[44:47], s99 offen offset:2048  lds
    v_mfma_f32_16x16x32_bf16 v[178:181], v[56:59], v[244:247], v[178:181]
    v_mfma_f32_16x16x32_bf16 v[184:187], v[48:51], v[244:247], v[184:187]
    s_waitcnt lgkmcnt(15)
    v_mfma_f32_16x16x32_bf16 v[160:163], v[84:87], v[248:251], v[160:163]
    ds_read_b64 v[240:241], v114 offset:2048
    buffer_load_dwordx4 v35, s[44:47], s99 offen offset:3072  lds
    v_mfma_f32_16x16x32_bf16 v[166:169], v[76:79], v[248:251], v[166:169]
    ds_read_b64 v[242:243], v118 offset:2048
    s_add_u32 s99, s95, 688128
    v_mfma_f32_16x16x32_bf16 v[172:175], v[68:71], v[248:251], v[172:175]
    v_mfma_f32_16x16x32_bf16 v[178:181], v[52:55], v[248:251], v[178:181]
    s_waitcnt lgkmcnt(2)
    s_add_u32 m0, s98, 8192
    s_nop 0
    buffer_load_dwordx4 v32, s[44:47], s99 offen offset:0  lds
    v_mfma_f32_16x16x32_bf16 v[160:163], v[80:83], v[252:255], v[160:163]
    ds_read_b64 v[244:245], v115 offset:2304
    s_waitcnt vmcnt(9)
    ds_read_b64_tr_b16 a[48:49], v36 offset:12288
    v_mfma_f32_16x16x32_bf16 v[166:169], v[72:75], v[252:255], v[166:169]
    ds_read_b64 v[246:247], v119 offset:2304
    ds_read_b64_tr_b16 a[50:51], v36 offset:14336
    v_mfma_f32_16x16x32_bf16 v[172:175], v[64:67], v[252:255], v[172:175]
    ds_read_b64_tr_b16 a[52:53], v37 offset:12288
    ds_read_b64_tr_b16 a[54:55], v37 offset:14336
    v_mfma_f32_16x16x32_bf16 v[178:181], v[48:51], v[252:255], v[178:181]
    buffer_load_dwordx4 v33, s[44:47], s99 offen offset:1024  lds
    ds_read_b64_tr_b16 a[56:57], v36 offset:13312
    v_mfma_f32_16x16x32_bf16 v[160:163], v[76:79], v[136:139], v[160:163]
    ds_read_b64 v[248:249], v112 offset:2560
    ds_read_b64_tr_b16 a[58:59], v36 offset:15360
    v_mfma_f32_16x16x32_bf16 v[166:169], v[68:71], v[136:139], v[166:169]
    ds_read_b64 v[250:251], v116 offset:2560
    ds_read_b64_tr_b16 a[60:61], v37 offset:13312
    v_mfma_f32_16x16x32_bf16 v[172:175], v[60:63], v[136:139], v[172:175]
    ds_read_b64_tr_b16 a[62:63], v37 offset:15360
    buffer_load_dwordx4 v34, s[44:47], s99 offen offset:2048  lds
    v_mfma_f32_16x16x32_bf16 v[160:163], v[72:75], v[140:143], v[160:163]
    ds_read_b64 v[252:253], v113 offset:2816
    v_mfma_f32_16x16x32_bf16 v[166:169], v[64:67], v[140:143], v[166:169]
    ds_read_b64 v[254:255], v117 offset:2816
    v_mfma_f32_16x16x32_bf16 v[172:175], v[56:59], v[140:143], v[172:175]
    s_mov_b64 exec, 1
    v_mov_b32 v2, 3
    buffer_store_dword v2, off, s[8:11], s85
    buffer_store_dword v2, off, s[8:11], s83 sc1
    s_mov_b64 exec, -1
    buffer_load_dwordx4 v35, s[44:47], s99 offen offset:3072  lds
    v_mfma_f32_16x16x32_bf16 v[160:163], v[68:71], v[144:147], v[160:163]
    ds_read_b64 v[136:137], v115 offset:0
    v_mfma_f32_16x16x32_bf16 v[166:169], v[60:63], v[144:147], v[166:169]
    ds_read_b64 v[138:139], v119 offset:0
    v_mfma_f32_16x16x32_bf16 v[172:175], v[52:55], v[144:147], v[172:175]
    s_lshl_b32 s99, s2, 2
    s_add_u32 s99, s99, s3
    s_mul_i32 s99, s99, 1792
    v_min_u32 v2, 13, v0
    v_lshlrev_b32 v2, 7, v2
    buffer_load_dword v5, v2, s[48:51], s99 offen
    v_mfma_f32_16x16x32_bf16 v[160:163], v[64:67], v[148:151], v[160:163]
    ds_read_b64 v[140:141], v112 offset:256
    s_add_u32 s99, s95, 802816
    v_mfma_f32_16x16x32_bf16 v[166:169], v[56:59], v[148:151], v[166:169]
    ds_read_b64 v[142:143], v116 offset:256
    v_mfma_f32_16x16x32_bf16 v[172:175], v[48:51], v[148:151], v[172:175]
    s_waitcnt lgkmcnt(6)
    s_add_u32 m0, s98, 12288
    s_nop 0
    buffer_load_dwordx4 v32, s[44:47], s99 offen offset:0  lds
    v_mfma_f32_16x16x32_bf16 v[160:163], v[60:63], v[240:243], v[160:163]
    ds_read_b64 v[144:145], v113 offset:512
    s_waitcnt vmcnt(12)
    ds_read_b64_tr_b16 a[64:65], v36 offset:0
    v_mfma_f32_16x16x32_bf16 v[166:169], v[52:55], v[240:243], v[166:169]
    ds_read_b64 v[146:147], v117 offset:512
    ds_read_b64_tr_b16 a[66:67], v36 offset:2048
    v_mfma_f32_16x16x32_bf16 v[160:163], v[56:59], v[244:247], v[160:163]
    ds_read_b64 v[148:149], v114 offset:768
    ds_read_b64_tr_b16 a[68:69], v37 offset:0
    v_mfma_f32_16x16x32_bf16 v[166:169], v[48:51], v[244:247], v[166:169]
    ds_read_b64 v[150:151], v118 offset:768
    ds_read_b64_tr_b16 a[70:71], v37 offset:2048
    s_waitcnt lgkmcnt(12)
    v_mfma_f32_16x16x32_bf16 v[160:163], v[52:55], v[248:251], v[160:163]
    ds_read_b64 v[240:241], v115 offset:1024
    buffer_load_dwordx4 v33, s[44:47], s99 offen offset:1024  lds
    ds_read_b64 v[242:243], v119 offset:1024
    v_mfma_f32_16x16x32_bf16 v[160:163], v[48:51], v[252:255], v[160:163]
    ds_read_b64 v[244:245], v112 offset:1280
    ds_read_b64_tr_b16 a[72:73], v36 offset:1024
    ds_read_b64 v[246:247], v116 offset:1280
    s_waitcnt lgkmcnt(13)
    v_mfma_f32_16x16x32_bf16 v[190:193], v[92:95], v[136:139], 0
    ds_read_b64 v[248:249], v113 offset:1536
    ds_read_b64_tr_b16 a[74:75], v36 offset:3072
    v_mfma_f32_16x16x32_bf16 v[196:199], v[84:87], v[136:139], 0
    ds_read_b64 v[250:251], v117 offset:1536
    ds_read_b64_tr_b16 a[76:77], v37 offset:1024
    v_mfma_f32_16x16x32_bf16 v[202:205], v[76:79], v[136:139], 0
    ds_read_b64_tr_b16 a[78:79], v37 offset:3072
    buffer_load_dwordx4 v34, s[44:47], s99 offen offset:2048  lds
    v_mfma_f32_16x16x32_bf16 v[208:211], v[60:63], v[136:139], 0
    v_mfma_f32_16x16x32_bf16 v[214:217], v[52:55], v[136:139], 0
    v_mfma_f32_16x16x32_bf16 v[190:193], v[88:91], v[140:143], v[190:193]
    ds_read_b64 v[252:253], v114 offset:1792
    buffer_load_dwordx4 v35, s[44:47], s99 offen offset:3072  lds
    v_mfma_f32_16x16x32_bf16 v[196:199], v[80:83], v[140:143], v[196:199]
    ds_read_b64 v[254:255], v118 offset:1792
    s_add_u32 s99, s95, 917504
    v_mfma_f32_16x16x32_bf16 v[202:205], v[72:75], v[140:143], v[202:205]
    v_mfma_f32_16x16x32_bf16 v[208:211], v[56:59], v[140:143], v[208:211]
    s_waitcnt lgkmcnt(2)
    s_add_u32 m0, s98, 0
    s_nop 0
    buffer_load_dwordx4 v32, s[44:47], s99 offen offset:0  lds
    v_mfma_f32_16x16x32_bf16 v[214:217], v[48:51], v[140:143], v[214:217]
    s_waitcnt vmcnt(12)
    ds_read_b64_tr_b16 a[80:81], v36 offset:4096
    v_mfma_f32_16x16x32_bf16 v[190:193], v[84:87], v[144:147], v[190:193]
    ds_read_b64 v[136:137], v115 offset:2048
    ds_read_b64_tr_b16 a[82:83], v36 offset:6144
    v_mfma_f32_16x16x32_bf16 v[196:199], v[76:79], v[144:147], v[196:199]
    ds_read_b64 v[138:139], v119 offset:2048
    ds_read_b64_tr_b16 a[84:85], v37 offset:4096
    v_mfma_f32_16x16x32_bf16 v[202:205], v[68:71], v[144:147], v[202:205]
    ds_read_b64_tr_b16 a[86:87], v37 offset:6144
    buffer_load_dwordx4 v33, s[44:47], s99 offen offset:1024  lds
    v_mfma_f32_16x16x32_bf16 v[208:211], v[52:55], v[144:147], v[208:211]
    ds_read_b64_tr_b16 a[88:89], v36 offset:5120
    ds_read_b64_tr_b16 a[90:91], v36 offset:7168
    v_mfma_f32_16x16x32_bf16 v[190:193], v[80:83], v[148:151], v[190:193]
    ds_read_b64 v[140:141], v112 offset:2304
    ds_read_b64_tr_b16 a[92:93], v37 offset:5120
    v_mfma_f32_16x16x32_bf16 v[196:199], v[72:75], v[148:151], v[196:199]
    ds_read_b64 v[142:143], v116 offset:2304
    ds_read_b64_tr_b16 a[94:95], v37 offset:7168
    v_mfma_f32_16x16x32_bf16 v[202:205], v[64:67], v[148:151], v[202:205]
    buffer_load_dwordx4 v34, s[44:47], s99 offen offset:2048  lds
    v_mfma_f32_16x16x32_bf16 v[208:211], v[48:51], v[148:151], v[208:211]
    v_mfma_f32_16x16x32_bf16 v[190:193], v[76:79], v[240:243], v[190:193]
    ds_read_b64 v[144:145], v113 offset:2560
    v_mfma_f32_16x16x32_bf16 v[196:199], v[68:71], v[240:243], v[196:199]
    ds_read_b64 v[146:147], v117 offset:2560
    buffer_load_dwordx4 v35, s[44:47], s99 offen offset:3072  lds
    v_mfma_f32_16x16x32_bf16 v[202:205], v[60:63], v[240:243], v[202:205]
    s_add_u32 s99, s95, 1032192
    v_mfma_f32_16x16x32_bf16 v[190:193], v[72:75], v[244:247], v[190:193]
    ds_read_b64 v[148:149], v114 offset:2816
    v_mfma_f32_16x16x32_bf16 v[196:199], v[64:67], v[244:247], v[196:199]
    ds_read_b64 v[150:151], v118 offset:2816
    s_waitcnt lgkmcnt(4)
    s_add_u32 m0, s98, 4096
    s_nop 0
    buffer_load_dwordx4 v32, s[44:47], s99 offen offset:0  lds
    v_mfma_f32_16x16x32_bf16 v[202:205], v[56:59], v[244:247], v[202:205]
    s_waitcnt vmcnt(10)
    ds_read_b64_tr_b16 a[96:97], v36 offset:8192
    v_mfma_f32_16x16x32_bf16 v[190:193], v[68:71], v[248:251], v[190:193]
    ds_read_b64 v[240:241], v112 offset:0
    ds_read_b64_tr_b16 a[98:99], v36 offset:10240
    v_mfma_f32_16x16x32_bf16 v[196:199], v[60:63], v[248:251], v[196:199]
    ds_read_b64 v[242:243], v116 offset:0
    ds_read_b64_tr_b16 a[100:101], v37 offset:8192
    v_mfma_f32_16x16x32_bf16 v[202:205], v[52:55], v[248:251], v[202:205]
    ds_read_b64_tr_b16 a[102:103], v37 offset:10240
    buffer_load_dwordx4 v33, s[44:47], s99 offen offset:1024  lds
    v_mfma_f32_16x16x32_bf16 v[190:193], v[64:67], v[252:255], v[190:193]
    ds_read_b64 v[244:245], v113 offset:256
    ds_read_b64_tr_b16 a[104:105], v36 offset:9216
    v_mfma_f32_16x16x32_bf16 v[196:199], v[56:59], v[252:255], v[196:199]
    ds_read_b64 v[246:247], v117 offset:256
    ds_read_b64_tr_b16 a[106:107], v36 offset:11264
    v_mfma_f32_16x16x32_bf16 v[202:205], v[48:51], v[252:255], v[202:205]
    ds_read_b64_tr_b16 a[108:109], v37 offset:9216
    ds_read_b64_tr_b16 a[110:111], v37 offset:11264
    v_mfma_f32_16x16x32_bf16 v[190:193], v[60:63], v[136:139], v[190:193]
    ds_read_b64 v[248:249], v114 offset:512
    buffer_load_dwordx4 v34, s[44:47], s99 offen offset:2048  lds
    v_mfma_f32_16x16x32_bf16 v[196:199], v[52:55], v[136:139], v[196:199]
    ds_read_b64 v[250:251], v118 offset:512
    v_mfma_f32_16x16x32_bf16 v[190:193], v[56:59], v[140:143], v[190:193]
    ds_read_b64 v[252:253], v115 offset:768
    v_mfma_f32_16x16x32_bf16 v[196:199], v[48:51], v[140:143], v[196:199]
    ds_read_b64 v[254:255], v119 offset:768
    buffer_load_dwordx4 v35, s[44:47], s99 offen offset:3072  lds
    s_waitcnt lgkmcnt(15)
    v_mfma_f32_16x16x32_bf16 v[190:193], v[52:55], v[144:147], v[190:193]
    ds_read_b64 v[136:137], v112 offset:1024
    s_add_u32 s99, s95, 1146880
    ds_read_b64 v[138:139], v116 offset:1024
    v_mfma_f32_16x16x32_bf16 v[190:193], v[48:51], v[148:151], v[190:193]
    ds_read_b64 v[140:141], v113 offset:1280
    ds_read_b64 v[142:143], v117 offset:1280
    s_waitcnt lgkmcnt(11)
    v_mfma_f32_16x16x32_bf16 v[162:165], v[92:95], v[240:243], v[162:165]
    ds_read_b64 v[144:145], v114 offset:1536
    s_waitcnt lgkmcnt(9)
    s_add_u32 m0, s98, 8192
    s_nop 0
    buffer_load_dwordx4 v32, s[44:47], s99 offen offset:0  lds
    v_mfma_f32_16x16x32_bf16 v[168:171], v[84:87], v[240:243], v[168:171]
    ds_read_b64 v[146:147], v118 offset:1536
    s_waitcnt vmcnt(9)
    ds_read_b64_tr_b16 a[112:113], v36 offset:12288
    v_mfma_f32_16x16x32_bf16 v[174:177], v[76:79], v[240:243], v[174:177]
    ds_read_b64_tr_b16 a[114:115], v36 offset:14336
    ds_read_b64_tr_b16 a[116:117], v37 offset:12288
    v_mfma_f32_16x16x32_bf16 v[180:183], v[60:63], v[240:243], v[180:183]
    ds_read_b64_tr_b16 a[118:119], v37 offset:14336
    buffer_load_dwordx4 v33, s[44:47], s99 offen offset:1024  lds
    v_mfma_f32_16x16x32_bf16 v[186:189], v[52:55], v[240:243], v[186:189]
    ds_read_b64_tr_b16 a[120:121], v36 offset:13312
    ds_read_b64_tr_b16 a[122:123], v36 offset:15360
    v_mfma_f32_16x16x32_bf16 v[162:165], v[88:91], v[244:247], v[162:165]
    ds_read_b64 v[148:149], v115 offset:1792
    ds_read_b64_tr_b16 a[124:125], v37 offset:13312
    v_mfma_f32_16x16x32_bf16 v[168:171], v[80:83], v[244:247], v[168:171]
    ds_read_b64 v[150:151], v119 offset:1792
    ds_read_b64_tr_b16 a[126:127], v37 offset:15360
    v_mfma_f32_16x16x32_bf16 v[174:177], v[72:75], v[244:247], v[174:177]
    buffer_load_dwordx4 v34, s[44:47], s99 offen offset:2048  lds
    v_mfma_f32_16x16x32_bf16 v[180:183], v[56:59], v[244:247], v[180:183]
    v_mfma_f32_16x16x32_bf16 v[186:189], v[48:51], v[244:247], v[186:189]
    s_waitcnt lgkmcnt(15)
    v_mfma_f32_16x16x32_bf16 v[162:165], v[84:87], v[248:251], v[162:165]
    ds_read_b64 v[240:241], v112 offset:2048
    buffer_load_dwordx4 v35, s[44:47], s99 offen offset:3072  lds
    v_mfma_f32_16x16x32_bf16 v[168:171], v[76:79], v[248:251], v[168:171]
    ds_read_b64 v[242:243], v116 offset:2048
    v_mfma_f32_16x16x32_bf16 v[174:177], v[68:71], v[248:251], v[174:177]
    v_mfma_f32_16x16x32_bf16 v[180:183], v[52:55], v[248:251], v[180:183]
    s_lshr_b32 s99, s2, 3
    s_lshl_b32 s99, s99, 2
    s_add_u32 s99, s99, s3
    s_mul_i32 s99, s99, 14336
    v_min_u32 v2, 13, v0
    v_lshlrev_b32_e64 v2, 10, v2
    buffer_load_dword v5, v2, s[48:51], s99 offen offset:384
    v_mfma_f32_16x16x32_bf16 v[162:165], v[80:83], v[252:255], v[162:165]
    ds_read_b64 v[244:245], v113 offset:2304
    s_add_u32 s99, s95, 1261568
    v_mfma_f32_16x16x32_bf16 v[168:171], v[72:75], v[252:255], v[168:171]
    ds_read_b64 v[246:247], v117 offset:2304
    v_mfma_f32_16x16x32_bf16 v[174:177], v[64:67], v[252:255], v[174:177]
    s_waitcnt lgkmcnt(4)
    s_add_u32 m0, s98, 12288
    s_nop 0
    buffer_load_dwordx4 v32, s[44:47], s99 offen offset:0  lds
    v_mfma_f32_16x16x32_bf16 v[180:183], v[48:51], v[252:255], v[180:183]
    s_waitcnt vmcnt(10)
    ds_read_b64_tr_b16 a[128:129], v36 offset:0
    v_mfma_f32_16x16x32_bf16 v[162:165], v[76:79], v[136:139], v[162:165]
    ds_read_b64 v[248:249], v114 offset:2560
    ds_read_b64_tr_b16 a[130:131], v36 offset:2048
    v_mfma_f32_16x16x32_bf16 v[168:171], v[68:71], v[136:139], v[168:171]
    ds_read_b64 v[250:251], v118 offset:2560
    ds_read_b64_tr_b16 a[132:133], v37 offset:0
    v_mfma_f32_16x16x32_bf16 v[174:177], v[60:63], v[136:139], v[174:177]
    ds_read_b64_tr_b16 a[134:135], v37 offset:2048
    buffer_load_dwordx4 v33, s[44:47], s99 offen offset:1024  lds
    v_mfma_f32_16x16x32_bf16 v[162:165], v[72:75], v[140:143], v[162:165]
    ds_read_b64 v[252:253], v115 offset:2816
    ds_read_b64_tr_b16 a[136:137], v36 offset:1024
    v_mfma_f32_16x16x32_bf16 v[168:171], v[64:67], v[140:143], v[168:171]
    ds_read_b64 v[254:255], v119 offset:2816
    ds_read_b64_tr_b16 a[138:139], v36 offset:3072
    v_mfma_f32_16x16x32_bf16 v[174:177], v[56:59], v[140:143], v[174:177]
    ds_read_b64_tr_b16 a[140:141], v37 offset:1024
    ds_read_b64_tr_b16 a[142:143], v37 offset:3072
    v_mfma_f32_16x16x32_bf16 v[162:165], v[68:71], v[144:147], v[162:165]
    ds_read_b64 v[136:137], v113 offset:0
    ds_read_u16_d16_hi v220, v30 offset:2560
    buffer_load_dwordx4 v34, s[44:47], s99 offen offset:2048  lds
    v_mfma_f32_16x16x32_bf16 v[168:171], v[60:63], v[144:147], v[168:171]
    ds_read_b64 v[138:139], v117 offset:0
    v_mfma_f32_16x16x32_bf16 v[174:177], v[52:55], v[144:147], v[174:177]
    ds_read_u16_d16_hi v221, v31 offset:2560
    v_mfma_f32_16x16x32_bf16 v[162:165], v[64:67], v[148:151], v[162:165]
    ds_read_b64 v[140:141], v114 offset:256
    buffer_load_dwordx4 v35, s[44:47], s99 offen offset:3072  lds
    v_mfma_f32_16x16x32_bf16 v[168:171], v[56:59], v[148:151], v[168:171]
    ds_read_b64 v[142:143], v118 offset:256
    ds_read_u16_d16_hi v222, v28 offset:2560
    s_add_u32 s99, s95, 1376256
    v_mfma_f32_16x16x32_bf16 v[174:177], v[48:51], v[148:151], v[174:177]
    s_waitcnt lgkmcnt(15)
    v_mfma_f32_16x16x32_bf16 v[162:165], v[60:63], v[240:243], v[162:165]
    ds_read_b64 v[144:145], v115 offset:512
    ds_read_u16_d16_hi v223, v29 offset:2560
    s_waitcnt lgkmcnt(9)
    s_add_u32 m0, s98, 0
    s_nop 0
    buffer_load_dwordx4 v32, s[44:47], s99 offen offset:0  lds
    v_mfma_f32_16x16x32_bf16 v[168:171], v[52:55], v[240:243], v[168:171]
    ds_read_b64 v[146:147], v119 offset:512
    buffer_load_dword v24, v13, s[8:11], s84 offen sc1
    s_waitcnt vmcnt(11)
    ds_read_b64_tr_b16 a[144:145], v36 offset:4096
    v_mfma_f32_16x16x32_bf16 v[162:165], v[56:59], v[244:247], v[162:165]
    ds_read_b64 v[148:149], v112 offset:768
    ds_read_u16_d16_hi v224, v28 offset:2048
    ds_read_b64_tr_b16 a[146:147], v36 offset:6144
    v_mfma_f32_16x16x32_bf16 v[168:171], v[48:51], v[244:247], v[168:171]
    ds_read_b64 v[150:151], v116 offset:768
    ds_read_b64_tr_b16 a[148:149], v37 offset:4096
    v_mfma_f32_16x16x32_bf16 v[162:165], v[52:55], v[248:251], v[162:165]
    ds_read_b64 v[240:241], v113 offset:1024
    ds_read_u16_d16_hi v225, v29 offset:2048
    ds_read_b64_tr_b16 a[150:151], v37 offset:6144
    ds_read_b64 v[242:243], v117 offset:1024
    v_mfma_f32_16x16x32_bf16 v[162:165], v[48:51], v[252:255], v[162:165]
    ds_read_b64 v[244:245], v114 offset:1280
    buffer_load_dwordx4 v33, s[44:47], s99 offen offset:1024  lds
    ds_read_b64 v[246:247], v118 offset:1280
    s_waitcnt lgkmcnt(15)
    v_mfma_f32_16x16x32_bf16 v[192:195], v[92:95], v[136:139], v[192:195]
    ds_read_b64 v[248:249], v115 offset:1536
    ds_read_u16_d16_hi v226, v30 offset:2048
    ds_read_b64_tr_b16 a[152:153], v36 offset:5120
    v_mfma_f32_16x16x32_bf16 v[198:201], v[84:87], v[136:139], v[198:201]
    ds_read_b64 v[250:251], v119 offset:1536
    ds_read_b64_tr_b16 a[154:155], v36 offset:7168
    v_mfma_f32_16x16x32_bf16 v[204:207], v[76:79], v[136:139], v[204:207]
    ds_read_u16_d16_hi v227, v31 offset:2048
    ds_read_b64_tr_b16 a[156:157], v37 offset:5120
    v_mfma_f32_16x16x32_bf16 v[210:213], v[60:63], v[136:139], v[210:213]
    ds_read_b64_tr_b16 a[158:159], v37 offset:7168
    buffer_load_dwordx4 v34, s[44:47], s99 offen offset:2048  lds
    v_mfma_f32_16x16x32_bf16 v[216:219], v[52:55], v[136:139], v[216:219]
    ds_read_u16_d16_hi v228, v30 offset:1536
    v_mfma_f32_16x16x32_bf16 v[192:195], v[88:91], v[140:143], v[192:195]
    ds_read_b64 v[252:253], v112 offset:1792
    v_mfma_f32_16x16x32_bf16 v[198:201], v[80:83], v[140:143], v[198:201]
    ds_read_b64 v[254:255], v116 offset:1792
    ds_read_u16_d16_hi v229, v31 offset:1536
    buffer_load_dwordx4 v35, s[44:47], s99 offen offset:3072  lds
    v_mfma_f32_16x16x32_bf16 v[204:207], v[72:75], v[140:143], v[204:207]
    s_add_u32 s99, s95, 1490944
    v_mfma_f32_16x16x32_bf16 v[210:213], v[56:59], v[140:143], v[210:213]
    ds_read_u16_d16_hi v230, v28 offset:1536
    v_mfma_f32_16x16x32_bf16 v[216:219], v[48:51], v[140:143], v[216:219]
    s_waitcnt lgkmcnt(5)
    s_add_u32 m0, s98, 4096
    s_nop 0
    buffer_load_dwordx4 v32, s[44:47], s99 offen offset:0  lds
    v_mfma_f32_16x16x32_bf16 v[192:195], v[84:87], v[144:147], v[192:195]
    ds_read_b64 v[136:137], v113 offset:2048
    ds_read_u16_d16_hi v231, v29 offset:1536
    s_waitcnt vmcnt(11)
    ds_read_b64_tr_b16 a[160:161], v36 offset:8192
    v_mfma_f32_16x16x32_bf16 v[198:201], v[76:79], v[144:147], v[198:201]
    ds_read_b64 v[138:139], v117 offset:2048
    ds_read_b64_tr_b16 a[162:163], v36 offset:10240
    v_mfma_f32_16x16x32_bf16 v[204:207], v[68:71], v[144:147], v[204:207]
    ds_read_u16_d16_hi v232, v30 offset:512
    ds_read_b64_tr_b16 a[164:165], v37 offset:8192
    v_mfma_f32_16x16x32_bf16 v[210:213], v[52:55], v[144:147], v[210:213]
    ds_read_b64_tr_b16 a[166:167], v37 offset:10240
    buffer_load_dwordx4 v33, s[44:47], s99 offen offset:1024  lds
    v_mfma_f32_16x16x32_bf16 v[192:195], v[80:83], v[148:151], v[192:195]
    ds_read_b64 v[140:141], v114 offset:2304
    ds_read_u16_d16_hi v233, v31 offset:512
    ds_read_b64_tr_b16 a[168:169], v36 offset:9216
    v_mfma_f32_16x16x32_bf16 v[198:201], v[72:75], v[148:151], v[198:201]
    ds_read_b64 v[142:143], v118 offset:2304
    ds_read_b64_tr_b16 a[170:171], v36 offset:11264
    v_mfma_f32_16x16x32_bf16 v[204:207], v[64:67], v[148:151], v[204:207]
    ds_read_u16_d16_hi v234, v28 offset:512
    ds_read_b64_tr_b16 a[172:173], v37 offset:9216
    v_mfma_f32_16x16x32_bf16 v[210:213], v[48:51], v[148:151], v[210:213]
    s_waitcnt vmcnt(5)
    v_cmp_gt_u32 vcc, 3, v24
    s_cbranch_vccnz chk_11_slow
chk_11_ok:
    ds_read_b64_tr_b16 a[174:175], v37 offset:11264
    v_mfma_f32_16x16x32_bf16 v[192:195], v[76:79], v[240:243], v[192:195]
    ds_read_b64 v[144:145], v115 offset:2560
    buffer_load_dwordx2 v[152:153], v22, s[8:11], s18 offen offset:0 sc1
    ds_read_u16_d16_hi v235, v29 offset:512
    buffer_load_dwordx4 v34, s[44:47], s99 offen offset:2048  lds
    v_mfma_f32_16x16x32_bf16 v[198:201], v[68:71], v[240:243], v[198:201]
    ds_read_b64 v[146:147], v119 offset:2560
    v_mfma_f32_16x16x32_bf16 v[204:207], v[60:63], v[240:243], v[204:207]
    buffer_load_dwordx2 v[154:155], v22, s[8:11], s18 offen offset:2048 sc1
    ds_read_u16_d16_hi v236, v28 offset:0
    v_mfma_f32_16x16x32_bf16 v[192:195], v[72:75], v[244:247], v[192:195]
    ds_read_b64 v[148:149], v112 offset:2816
    buffer_load_dwordx4 v35, s[44:47], s99 offen offset:3072  lds
    v_mfma_f32_16x16x32_bf16 v[198:201], v[64:67], v[244:247], v[198:201]
    ds_read_b64 v[150:151], v116 offset:2816
    buffer_load_dwordx2 v[156:157], v22, s[8:11], s19 offen offset:0 sc1
    ds_read_u16_d16_hi v237, v29 offset:0
    s_add_u32 s99, s95, 1605632
    v_mfma_f32_16x16x32_bf16 v[204:207], v[56:59], v[244:247], v[204:207]
    s_waitcnt lgkmcnt(15)
    v_mfma_f32_16x16x32_bf16 v[192:195], v[68:71], v[248:251], v[192:195]
    buffer_load_dwordx2 v[158:159], v22, s[8:11], s19 offen offset:2048 sc1
    ds_read_u16_d16_hi v238, v30 offset:0
    s_waitcnt lgkmcnt(8)
    s_add_u32 m0, s98, 8192
    s_nop 0
    buffer_load_dwordx4 v32, s[44:47], s99 offen offset:0  lds
    v_mfma_f32_16x16x32_bf16 v[198:201], v[60:63], v[248:251], v[198:201]
    ds_read_b64_tr_b16 a[176:177], v36 offset:12288
    ds_read_b64_tr_b16 a[178:179], v36 offset:14336
    v_mfma_f32_16x16x32_bf16 v[204:207], v[52:55], v[248:251], v[204:207]
    ds_read_u16_d16_hi v239, v31 offset:0
    ds_read_b64_tr_b16 a[180:181], v37 offset:12288
    v_mfma_f32_16x16x32_bf16 v[192:195], v[64:67], v[252:255], v[192:195]
    ds_read_b64_tr_b16 a[182:183], v37 offset:14336
    buffer_load_dwordx4 v33, s[44:47], s99 offen offset:1024  lds
    v_mfma_f32_16x16x32_bf16 v[198:201], v[56:59], v[252:255], v[198:201]
    ds_read_b64_tr_b16 a[184:185], v36 offset:13312
    ds_read_b64_tr_b16 a[186:187], v36 offset:15360
    v_mfma_f32_16x16x32_bf16 v[204:207], v[48:51], v[252:255], v[204:207]
    ds_read_b64_tr_b16 a[188:189], v37 offset:13312
    ds_read_b64_tr_b16 a[190:191], v37 offset:15360
    v_mfma_f32_16x16x32_bf16 v[192:195], v[60:63], v[136:139], v[192:195]
    buffer_load_dwordx4 v34, s[44:47], s99 offen offset:2048  lds
    v_mfma_f32_16x16x32_bf16 v[198:201], v[52:55], v[136:139], v[198:201]
    v_mfma_f32_16x16x32_bf16 v[192:195], v[56:59], v[140:143], v[192:195]
    v_mfma_f32_16x16x32_bf16 v[198:201], v[48:51], v[140:143], v[198:201]
    buffer_load_dwordx4 v35, s[44:47], s99 offen offset:3072  lds
    s_waitcnt lgkmcnt(11)
    v_mfma_f32_16x16x32_bf16 v[192:195], v[52:55], v[144:147], v[192:195]
    v_mfma_f32_16x16x32_bf16 v[192:195], v[48:51], v[148:151], v[192:195]
    s_xor_b32 s22, s17, 6144
    buffer_load_dwordx4 v[108:111], v3, s[8:11], s22 offen offset:1024 sc1
    v_add_u32 v26, 4, v15
    s_nop 4
    v_add_f32 v164, v164, v193
    v_add_f32 v165, v165, v194
    ds_write2st64_b32 v26, v164, v165 offset0:5 offset1:14
    ds_write_b32 v26, v195 offset:5888
    v_add_f32 v170, v170, v199
    v_add_f32 v171, v171, v200
    ds_write2st64_b32 v26, v170, v171 offset0:4 offset1:13
    ds_write_b32 v26, v201 offset:5632
    v_add_f32 v176, v176, v205
    v_add_f32 v177, v177, v206
    ds_write2st64_b32 v26, v176, v177 offset0:3 offset1:12
    ds_write_b32 v26, v207 offset:5376
    v_add_f32 v182, v182, v211
    v_add_f32 v183, v183, v212
    ds_write2st64_b32 v26, v182, v183 offset0:1 offset1:10
    ds_write_b32 v26, v213 offset:4864
    v_add_f32 v188, v188, v217
    v_add_f32 v189, v189, v218
    ds_write2st64_b32 v26, v188, v189 offset0:0 offset1:9
    ds_write_b32 v26, v219 offset:4608
    v_add_f32 v161, v161, v190
    v_add_f32 v162, v162, v191
    v_add_f32 v163, v163, v192
    v_add_f32 v167, v167, v196
    v_add_f32 v168, v168, v197
    v_add_f32 v169, v169, v198
    buffer_load_dwordx4 v[104:107], v3, s[8:11], s22 offen offset:0 sc1
    v_add_f32 v173, v173, v202
    v_add_f32 v174, v174, v203
    v_add_f32 v175, v175, v204
    v_add_f32 v179, v179, v208
    v_add_f32 v180, v180, v209
    v_add_f32 v181, v181, v210
    v_add_f32 v185, v185, v214
    v_add_f32 v186, v186, v215
    v_add_f32 v187, v187, v216
    s_waitcnt lgkmcnt(0)
    s_barrier
    ds_read2st64_b32 v[190:191], v15 offset0:5 offset1:14
    ds_read_b32 v192, v15 offset:5888
    s_xor_b32 s22, s17, 4096
    buffer_load_dwordx4 v[100:103], v3, s[8:11], s22 offen offset:1024 sc1
    ds_read2st64_b32 v[196:197], v15 offset0:4 offset1:13
    ds_read_b32 v198, v15 offset:5632
    ds_read2st64_b32 v[202:203], v15 offset0:3 offset1:12
    ds_read_b32 v204, v15 offset:5376
    ds_read2st64_b32 v[208:209], v15 offset0:1 offset1:10
    ds_read_b32 v210, v15 offset:4864
    ds_read2st64_b32 v[214:215], v15 offset0:0 offset1:9
    ds_read_b32 v216, v15 offset:4608
    v_fmac_f32 v160, v16, v220
    v_fmac_f32 v161, v16, v221
    v_fmac_f32 v162, v16, v222
    v_fmac_f32 v163, v16, v223
    v_fmac_f32 v166, v16, v224
    v_fmac_f32 v167, v16, v225
    buffer_load_dwordx4 v[96:99], v3, s[8:11], s22 offen offset:0 sc1
    v_fmac_f32 v168, v16, v226
    v_fmac_f32 v169, v16, v227
    v_fmac_f32 v172, v16, v228
    v_fmac_f32 v173, v16, v229
    v_fmac_f32 v174, v16, v230
    v_fmac_f32 v175, v16, v231
    v_fmac_f32 v178, v16, v232
    v_fmac_f32 v179, v16, v233
    v_fmac_f32 v180, v16, v234
    v_fmac_f32 v181, v16, v235
    v_fmac_f32 v184, v16, v236
    v_fmac_f32 v185, v16, v237
    v_fmac_f32 v186, v16, v238
    v_fmac_f32 v187, v16, v239
    s_waitcnt lgkmcnt(8)
    v_add_f32 v160, v160, v190
    s_xor_b32 s22, s17, 2048
    buffer_load_dwordx4 v[92:95], v3, s[8:11], s22 offen offset:1024 sc1
    v_add_f32 v161, v161, v191
    v_add_f32 v162, v162, v192
    v_cvt_pk_bf16_f32 v160, v160, v161
    v_cvt_pk_bf16_f32 v161, v162, v163
    s_waitcnt lgkmcnt(6)
    v_add_f32 v166, v166, v196
    v_add_f32 v167, v167, v197
    v_add_f32 v168, v168, v198
    v_cvt_pk_bf16_f32 v166, v166, v167
    v_cvt_pk_bf16_f32 v167, v168, v169
    s_waitcnt lgkmcnt(4)
    v_add_f32 v172, v172, v202
    v_add_f32 v173, v173, v203
    v_add_f32 v174, v174, v204
    buffer_load_dwordx4 v[88:91], v3, s[8:11], s22 offen offset:0 sc1
    v_cvt_pk_bf16_f32 v172, v172, v173
    v_cvt_pk_bf16_f32 v173, v174, v175
    s_waitcnt lgkmcnt(2)
    v_add_f32 v178, v178, v208
    v_add_f32 v179, v179, v209
    v_add_f32 v180, v180, v210
    v_cvt_pk_bf16_f32 v178, v178, v179
    v_cvt_pk_bf16_f32 v179, v180, v181
    s_waitcnt lgkmcnt(0)
    v_add_f32 v184, v184, v214
    v_add_f32 v185, v185, v215
    v_add_f32 v186, v186, v216
    v_cvt_pk_bf16_f32 v184, v184, v185
    v_cvt_pk_bf16_f32 v185, v186, v187
    s_xor_b32 s22, s17, 0
    buffer_load_dwordx4 v[84:87], v3, s[8:11], s22 offen offset:1024 sc1
    buffer_load_dwordx4 v[80:83], v3, s[8:11], s22 offen offset:0 sc1
    buffer_store_dwordx2 v[160:161], v17, s[8:11], s21 offen offset:2560 sc1
    buffer_store_dwordx2 v[166:167], v17, s[8:11], s21 offen offset:2048 sc1
    buffer_store_dwordx2 v[172:173], v17, s[8:11], s21 offen offset:1536 sc1
    buffer_store_dwordx2 v[178:179], v17, s[8:11], s21 offen offset:512 sc1
    buffer_store_dwordx2 v[184:185], v17, s[8:11], s21 offen offset:0 sc1
join_9:
    s_lshl_b32 s64, s3, 13
    v_add_u32 v24, s64, v3
    s_waitcnt vmcnt(17)
    v_add_f32 v152, v152, v154
    v_add_f32 v153, v153, v155
    v_add_f32 v156, v156, v158
    v_add_f32 v157, v157, v159
    v_add_f32 v152, v152, v156
    v_add_f32 v153, v153, v157
    s_nop 1
    v_permlane32_swap_b32 v152, v153
    v_add_f32 v152, v152, v153
    v_mov_b32 v153, v152
    s_nop 1
    v_permlane32_swap_b32 v152, v153
    v_mul_f32 v154, 0xbb000000, v152
    v_cvt_pk_bf16_f32 v154, v154, v154
    v_and_b32 v154, s71, v154
    s_waitcnt vmcnt(10)
    buffer_load_dwordx2 v[248:249], v22, s[8:11], s18 offen offset:512 sc1
    v_dot2_f32_bf16 v112, v108, s69, v154
    v_dot2_f32_bf16 v113, v108, s70, v154
    v_dot2_f32_bf16 v114, v109, s69, v154
    v_dot2_f32_bf16 v115, v109, s70, v154
    v_dot2_f32_bf16 v116, v110, s69, v154
    v_dot2_f32_bf16 v117, v110, s70, v154
    v_dot2_f32_bf16 v118, v111, s69, v154
    buffer_load_dwordx2 v[250:251], v22, s[8:11], s18 offen offset:2560 sc1
    v_dot2_f32_bf16 v119, v111, s70, v154
    v_cvt_pk_bf16_f32 v108, v112, v113
    v_cvt_pk_bf16_f32 v109, v114, v115
    v_cvt_pk_bf16_f32 v110, v116, v117
    v_cvt_pk_bf16_f32 v111, v118, v119
    ds_write_b128 v24, v[108:111] offset:7168
    s_waitcnt vmcnt(11)
    buffer_load_dwordx2 v[252:253], v22, s[8:11], s19 offen offset:512 sc1
    v_dot2_f32_bf16 v112, v104, s69, v154
    v_dot2_f32_bf16 v113, v104, s70, v154
    v_dot2_f32_bf16 v114, v105, s69, v154
    v_dot2_f32_bf16 v115, v105, s70, v154
    v_dot2_f32_bf16 v116, v106, s69, v154
    v_dot2_f32_bf16 v117, v106, s70, v154
    v_dot2_f32_bf16 v118, v107, s69, v154
    buffer_load_dwordx2 v[254:255], v22, s[8:11], s19 offen offset:2560 sc1
    v_dot2_f32_bf16 v119, v107, s70, v154
    v_cvt_pk_bf16_f32 v104, v112, v113
    v_cvt_pk_bf16_f32 v105, v114, v115
    v_cvt_pk_bf16_f32 v106, v116, v117
    v_cvt_pk_bf16_f32 v107, v118, v119
    ds_write_b128 v24, v[104:107] offset:6144
    s_waitcnt vmcnt(12)
    s_xor_b32 s22, s17, 38912
    buffer_load_dwordx4 v[76:79], v3, s[8:11], s22 offen offset:1024 sc1
    v_dot2_f32_bf16 v112, v100, s69, v154
    v_dot2_f32_bf16 v113, v100, s70, v154
    v_dot2_f32_bf16 v114, v101, s69, v154
    v_dot2_f32_bf16 v115, v101, s70, v154
    v_dot2_f32_bf16 v116, v102, s69, v154
    v_dot2_f32_bf16 v117, v102, s70, v154
    v_dot2_f32_bf16 v118, v103, s69, v154
    v_dot2_f32_bf16 v119, v103, s70, v154
    v_cvt_pk_bf16_f32 v100, v112, v113
    v_cvt_pk_bf16_f32 v101, v114, v115
    v_cvt_pk_bf16_f32 v102, v116, v117
    v_cvt_pk_bf16_f32 v103, v118, v119
    ds_write_b128 v24, v[100:103] offset:5120
    s_waitcnt vmcnt(12)
    buffer_load_dwordx4 v[72:75], v3, s[8:11], s22 offen offset:0 sc1
    v_dot2_f32_bf16 v112, v96, s69, v154
    v_dot2_f32_bf16 v113, v96, s70, v154
    v_dot2_f32_bf16 v114, v97, s69, v154
    v_dot2_f32_bf16 v115, v97, s70, v154
    v_dot2_f32_bf16 v116, v98, s69, v154
    v_dot2_f32_bf16 v117, v98, s70, v154
    v_dot2_f32_bf16 v118, v99, s69, v154
    v_dot2_f32_bf16 v119, v99, s70, v154
    v_cvt_pk_bf16_f32 v96, v112, v113
    v_cvt_pk_bf16_f32 v97, v114, v115
    v_cvt_pk_bf16_f32 v98, v116, v117
    v_cvt_pk_bf16_f32 v99, v118, v119
    ds_write_b128 v24, v[96:99] offset:4096
    s_waitcnt vmcnt(12)
    s_xor_b32 s22, s17, 36864
    buffer_load_dwordx4 v[68:71], v3, s[8:11], s22 offen offset:1024 sc1
    v_dot2_f32_bf16 v112, v92, s69, v154
    v_dot2_f32_bf16 v113, v92, s70, v154
    v_dot2_f32_bf16 v114, v93, s69, v154
    v_dot2_f32_bf16 v115, v93, s70, v154
    v_dot2_f32_bf16 v116, v94, s69, v154
    v_dot2_f32_bf16 v117, v94, s70, v154
    v_dot2_f32_bf16 v118, v95, s69, v154
    v_dot2_f32_bf16 v119, v95, s70, v154
    v_cvt_pk_bf16_f32 v92, v112, v113
    v_cvt_pk_bf16_f32 v93, v114, v115
    v_cvt_pk_bf16_f32 v94, v116, v117
    v_cvt_pk_bf16_f32 v95, v118, v119
    ds_write_b128 v24, v[92:95] offset:3072
    s_waitcnt vmcnt(12)
    buffer_load_dwordx4 v[64:67], v3, s[8:11], s22 offen offset:0 sc1
    v_dot2_f32_bf16 v112, v88, s69, v154
    v_dot2_f32_bf16 v113, v88, s70, v154
    v_dot2_f32_bf16 v114, v89, s69, v154
    v_dot2_f32_bf16 v115, v89, s70, v154
    v_dot2_f32_bf16 v116, v90, s69, v154
    v_dot2_f32_bf16 v117, v90, s70, v154
    v_dot2_f32_bf16 v118, v91, s69, v154
    v_dot2_f32_bf16 v119, v91, s70, v154
    v_cvt_pk_bf16_f32 v88, v112, v113
    v_cvt_pk_bf16_f32 v89, v114, v115
    v_cvt_pk_bf16_f32 v90, v116, v117
    v_cvt_pk_bf16_f32 v91, v118, v119
    ds_write_b128 v24, v[88:91] offset:2048
    s_waitcnt vmcnt(12)
    v_dot2_f32_bf16 v112, v84, s69, v154
    v_dot2_f32_bf16 v113, v84, s70, v154
    v_dot2_f32_bf16 v114, v85, s69, v154
    v_dot2_f32_bf16 v115, v85, s70, v154
    v_dot2_f32_bf16 v116, v86, s69, v154
    v_dot2_f32_bf16 v117, v86, s70, v154
    v_dot2_f32_bf16 v118, v87, s69, v154
    v_dot2_f32_bf16 v119, v87, s70, v154
    v_cvt_pk_bf16_f32 v84, v112, v113
    v_cvt_pk_bf16_f32 v85, v114, v115
    v_cvt_pk_bf16_f32 v86, v116, v117
    v_cvt_pk_bf16_f32 v87, v118, v119
    ds_write_b128 v24, v[84:87] offset:1024
    s_waitcnt vmcnt(11)
    v_dot2_f32_bf16 v112, v80, s69, v154
    v_dot2_f32_bf16 v113, v80, s70, v154
    v_dot2_f32_bf16 v114, v81, s69, v154
    v_dot2_f32_bf16 v115, v81, s70, v154
    v_dot2_f32_bf16 v116, v82, s69, v154
    v_dot2_f32_bf16 v117, v82, s70, v154
    v_dot2_f32_bf16 v118, v83, s69, v154
    v_dot2_f32_bf16 v119, v83, s70, v154
    v_cvt_pk_bf16_f32 v80, v112, v113
    v_cvt_pk_bf16_f32 v81, v114, v115
    v_cvt_pk_bf16_f32 v82, v116, v117
    v_cvt_pk_bf16_f32 v83, v118, v119
    ds_write_b128 v24, v[80:83] offset:0
    s_waitcnt lgkmcnt(0)
    s_barrier
    ds_read_b128 v[136:139], v3 offset:0
    ds_read_b128 v[140:143], v3 offset:1024
    ds_read_b128 v[144:147], v3 offset:2048
    s_waitcnt lgkmcnt(2)
    v_mfma_f32_32x32x16_bf16 v[80:95], a[0:3], v[136:139], 0
    s_xor_b32 s22, s17, 34816
    buffer_load_dwordx4 v[60:63], v3, s[8:11], s22 offen offset:1024 sc1
    v_mul_f32 v152, 0x3b000000, v152
    v_mul_f32 v153, 0x3b000000, v153
    v_fma_f32 v153, -v152, v152, v153
    v_max_f32_e64 v153, 0, v153
    v_mfma_f32_32x32x16_bf16 v[96:111], a[4:7], v[136:139], 0
    ds_read_b128 v[148:151], v3 offset:3072
    v_cvt_pk_bf16_f32 v153, v153, v153
    v_and_b32 v153, s71, v153
    v_add_f32 v153, 0x3727c5ac, v153
    v_cvt_pk_bf16_f32 v153, v153, v153
    s_waitcnt lgkmcnt(2)
    v_mfma_f32_32x32x16_bf16 v[80:95], a[8:11], v[140:143], v[80:95]
    buffer_load_dwordx4 v[56:59], v3, s[8:11], s22 offen offset:0 sc1
    v_and_b32 v153, s71, v153
    v_sqrt_f32_e64 v16, v153
    s_nop 0
    v_cvt_pk_bf16_f32 v16, v16, v16
    v_mfma_f32_32x32x16_bf16 v[96:111], a[12:15], v[140:143], v[96:111]
    ds_read_b128 v[136:139], v3 offset:4096
    v_and_b32 v16, s71, v16
    v_rcp_f32 v17, v16
    s_nop 0
    s_waitcnt lgkmcnt(2)
    v_mfma_f32_32x32x16_bf16 v[80:95], a[16:19], v[144:147], v[80:95]
    s_xor_b32 s22, s17, 32768
    buffer_load_dwordx4 v[52:55], v3, s[8:11], s22 offen offset:1024 sc1
    v_mul_f32 v15, 0xc0135761, v17
    v_mul_f32 v14, v17, v17
    v_mul_f32 v14, v14, v17
    v_mul_f32 v14, 0xbdd2d3e8, v14
    v_mfma_f32_32x32x16_bf16 v[96:111], a[20:23], v[144:147], v[96:111]
    ds_read_b128 v[140:143], v3 offset:5120
    s_waitcnt lgkmcnt(2)
    v_mfma_f32_32x32x16_bf16 v[80:95], a[24:27], v[148:151], v[80:95]
    buffer_load_dwordx4 v[48:51], v3, s[8:11], s22 offen offset:0 sc1
    v_mfma_f32_32x32x16_bf16 v[96:111], a[28:31], v[148:151], v[96:111]
    ds_read_b128 v[144:147], v3 offset:6144
    s_waitcnt lgkmcnt(2)
    v_mfma_f32_32x32x16_bf16 v[80:95], a[32:35], v[136:139], v[80:95]
    v_lshlrev_b32 v6, 11, v10
    v_lshl_add_u32 v6, v9, 2, v6
    s_lshl_b32 s64, s3, 8
    s_add_u32 s64, s64, s18
    buffer_load_dword v38, v6, s[8:11], s64 offen offset:128 sc1
    v_mfma_f32_32x32x16_bf16 v[96:111], a[36:39], v[136:139], v[96:111]
    ds_read_b128 v[148:151], v3 offset:7168
    s_waitcnt lgkmcnt(2)
    v_mfma_f32_32x32x16_bf16 v[80:95], a[40:43], v[140:143], v[80:95]
    buffer_load_dword v39, v6, s[8:11], s64 offen offset:1152 sc1
    s_waitcnt vmcnt(14)
    s_mov_b64 exec, 1
    v_mov_b32 v2, 4
    buffer_store_dword v2, off, s[8:11], s83 sc1
    s_mov_b64 exec, -1
    v_mfma_f32_32x32x16_bf16 v[96:111], a[44:47], v[140:143], v[96:111]
    ds_read_b128 v[136:139], v3 offset:8192
    s_waitcnt vmcnt(11)
    v_add_f32 v248, v248, v250
    v_add_f32 v249, v249, v251
    v_add_f32_e64 v252, v252, v254
    s_waitcnt lgkmcnt(2)
    v_mfma_f32_32x32x16_bf16 v[80:95], a[48:51], v[144:147], v[80:95]
    s_add_u32 s99, s95, 1720320
    s_add_u32 m0, s98, 12288
    s_nop 0
    buffer_load_dwordx4 v32, s[44:47], s99 offen offset:0  lds
    ds_read_b64_tr_b16 a[192:193], v36 offset:0
    ds_read_b64_tr_b16 a[194:195], v36 offset:2048
    ds_read_b64_tr_b16 a[196:197], v37 offset:0
    v_mfma_f32_32x32x16_bf16 v[96:111], a[52:55], v[144:147], v[96:111]
    ds_read_b128 v[140:143], v3 offset:9216
    ds_read_b64_tr_b16 a[198:199], v37 offset:2048
    v_add_f32 v253, v253, v255
    v_add_f32 v248, v248, v252
    buffer_load_dwordx4 v33, s[44:47], s99 offen offset:1024  lds
    s_waitcnt lgkmcnt(6)
    v_mfma_f32_32x32x16_bf16 v[80:95], a[56:59], v[148:151], v[80:95]
    ds_read_b64_tr_b16 a[200:201], v36 offset:1024
    ds_read_b64_tr_b16 a[202:203], v36 offset:3072
    ds_read_b64_tr_b16 a[204:205], v37 offset:1024
    ds_read_b64_tr_b16 a[206:207], v37 offset:3072
    v_add_f32 v249, v249, v253
    s_nop 1
    v_permlane32_swap_b32 v248, v249
    v_mfma_f32_32x32x16_bf16 v[96:111], a[60:63], v[148:151], v[96:111]
    ds_read_b128 v[144:147], v3 offset:10240
    v_add_f32 v248, v248, v249
    v_mov_b32 v249, v248
    buffer_load_dwordx4 v34, s[44:47], s99 offen offset:2048  lds
    s_nop 1
    v_permlane32_swap_b32 v248, v249
    s_waitcnt lgkmcnt(10)
    v_mfma_f32_32x32x16_bf16 v[80:95], a[64:67], v[136:139], v[80:95]
    v_mul_f32 v250, 0xbb000000, v248
    v_cvt_pk_bf16_f32 v250, v250, v250
    v_and_b32 v250, s71, v250
    s_waitcnt vmcnt(13)
    v_lshlrev_b32 v112, 16, v76
    v_and_b32 v113, s71, v76
    v_mfma_f32_32x32x16_bf16 v[96:111], a[68:71], v[136:139], v[96:111]
    ds_read_b128 v[148:151], v3 offset:11264
    v_add_f32 v112, v112, v250
    v_add_f32 v113, v113, v250
    v_cvt_pk_bf16_f32 v76, v112, v113
    v_lshlrev_b32 v114, 16, v77
    s_waitcnt lgkmcnt(7)
    v_mfma_f32_32x32x16_bf16 v[80:95], a[72:75], v[140:143], v[80:95]
    buffer_load_dwordx4 v35, s[44:47], s99 offen offset:3072  lds
    v_and_b32 v33, 127, v32
    v_lshrrev_b32_e64 v32, 3, v0
    v_lshl_add_u32 v32, v32, 10, v33
    v_add_u32 v33, 7168, v32
    v_add_u32 v34, 14336, v32
    v_add_u32 v35, 21504, v32
    s_add_u32 s99, s13, 0
    v_mfma_f32_32x32x16_bf16 v[96:111], a[76:79], v[140:143], v[96:111]
    ds_read_b128 v[136:139], v3 offset:12288
    v_and_b32 v115, s71, v77
    v_add_f32 v114, v114, v250
    v_add_f32 v115, v115, v250
    v_cvt_pk_bf16_f32 v77, v114, v115
    s_waitcnt lgkmcnt(2)
    v_mfma_f32_32x32x16_bf16 v[80:95], a[80:83], v[144:147], v[80:95]
    v_lshlrev_b32 v112, 16, v78
    s_add_u32 m0, s98, 0
    s_nop 0
    buffer_load_dwordx4 v32, s[48:51], s99 offen offset:0  lds
    ds_read_b64_tr_b16 a[208:209], v36 offset:4096
    ds_read_b64_tr_b16 a[210:211], v36 offset:6144
    ds_read_b64_tr_b16 a[212:213], v37 offset:4096
    v_mfma_f32_32x32x16_bf16 v[96:111], a[84:87], v[144:147], v[96:111]
    ds_read_b128 v[140:143], v3 offset:13312
    ds_read_b64_tr_b16 a[214:215], v37 offset:6144
    v_and_b32 v113, s71, v78
    v_add_f32 v112, v112, v250
    v_add_f32 v113, v113, v250
    s_waitcnt lgkmcnt(6)
    v_mfma_f32_32x32x16_bf16 v[80:95], a[88:91], v[148:151], v[80:95]
    v_cvt_pk_bf16_f32 v78, v112, v113
    v_lshlrev_b32 v114, 16, v79
    v_and_b32 v115, s71, v79
    v_add_f32 v114, v114, v250
    v_add_f32 v115, v115, v250
    v_cvt_pk_bf16_f32 v79, v114, v115
    v_mfma_f32_32x32x16_bf16 v[96:111], a[92:95], v[148:151], v[96:111]
    ds_read_b128 v[144:147], v3 offset:14336
    buffer_load_dwordx4 v33, s[48:51], s99 offen offset:1024  lds
    ds_read_b64_tr_b16 a[216:217], v36 offset:5120
    ds_read_b64_tr_b16 a[218:219], v36 offset:7168
    ds_read_b64_tr_b16 a[220:221], v37 offset:5120
    s_waitcnt lgkmcnt(9)
    v_mfma_f32_32x32x16_bf16 v[80:95], a[96:99], v[136:139], v[80:95]
    ds_read_b64_tr_b16 a[222:223], v37 offset:7168
    ds_write_b128 v24, v[76:79] offset:39936
    s_waitcnt vmcnt(15)
    v_lshlrev_b32 v112, 16, v72
    v_and_b32 v113, s71, v72
    v_add_f32 v112, v112, v250
    v_mfma_f32_32x32x16_bf16 v[96:111], a[100:103], v[136:139], v[96:111]
    ds_read_b128 v[148:151], v3 offset:15360
    v_add_f32 v113, v113, v250
    v_cvt_pk_bf16_f32 v72, v112, v113
    v_lshlrev_b32 v114, 16, v73
    buffer_load_dwordx4 v34, s[48:51], s99 offen offset:2048  lds
    s_waitcnt lgkmcnt(8)
    v_mfma_f32_32x32x16_bf16 v[80:95], a[104:107], v[140:143], v[80:95]
    v_and_b32 v115, s71, v73
    v_add_f32 v114, v114, v250
    v_add_f32 v115, v115, v250
    v_cvt_pk_bf16_f32 v73, v114, v115
    v_lshlrev_b32 v112, 16, v74
    v_and_b32 v113, s71, v74
    v_mfma_f32_32x32x16_bf16 v[96:111], a[108:111], v[140:143], v[96:111]
    ds_read_b128 v[136:139], v3 offset:16384
    v_add_f32 v112, v112, v250
    v_add_f32 v113, v113, v250
    v_cvt_pk_bf16_f32 v74, v112, v113
    v_lshlrev_b32 v114, 16, v75
    s_waitcnt lgkmcnt(7)
    v_mfma_f32_32x32x16_bf16 v[80:95], a[112:115], v[144:147], v[80:95]
    v_and_b32 v115, s71, v75
    buffer_load_dwordx4 v35, s[48:51], s99 offen offset:3072  lds
    s_add_u32 s99, s13, 32768
    v_add_f32 v114, v114, v250
    v_add_f32 v115, v115, v250
    v_cvt_pk_bf16_f32 v75, v114, v115
    v_mfma_f32_32x32x16_bf16 v[96:111], a[116:119], v[144:147], v[96:111]
    ds_read_b128 v[140:143], v3 offset:17408
    ds_write_b128 v24, v[72:75] offset:38912
    s_waitcnt vmcnt(16)
    v_lshlrev_b32 v112, 16, v68
    v_and_b32 v113, s71, v68
    s_waitcnt lgkmcnt(3)
    v_mfma_f32_32x32x16_bf16 v[80:95], a[120:123], v[148:151], v[80:95]
    v_add_f32 v112, v112, v250
    v_add_f32 v113, v113, v250
    v_cvt_pk_bf16_f32 v68, v112, v113
    v_lshlrev_b32 v114, 16, v69
    v_and_b32 v115, s71, v69
    v_add_f32_e64 v114, v114, v250
    v_mfma_f32_32x32x16_bf16 v[96:111], a[124:127], v[148:151], v[96:111]
    ds_read_b128 v[144:147], v3 offset:18432
    s_add_u32 m0, s98, 4096
    s_nop 0
    buffer_load_dwordx4 v32, s[48:51], s99 offen offset:0  lds
    ds_read_b64_tr_b16 a[224:225], v36 offset:8192
    ds_read_b64_tr_b16 a[226:227], v36 offset:10240
    s_waitcnt lgkmcnt(5)
    v_mfma_f32_32x32x16_bf16 v[80:95], a[128:131], v[136:139], v[80:95]
    ds_read_b64_tr_b16 a[228:229], v37 offset:8192
    ds_read_b64_tr_b16 a[230:231], v37 offset:10240
    v_add_f32 v115, v115, v250
    v_cvt_pk_bf16_f32 v69, v114, v115
    v_lshlrev_b32 v112, 16, v70
    v_and_b32 v113, s71, v70
    v_mfma_f32_32x32x16_bf16 v[96:111], a[132:135], v[136:139], v[96:111]
    ds_read_b128 v[148:151], v3 offset:19456
    v_add_f32 v112, v112, v250
    v_add_f32 v113, v113, v250
    v_cvt_pk_bf16_f32 v70, v112, v113
    buffer_load_dwordx4 v33, s[48:51], s99 offen offset:1024  lds
    s_waitcnt lgkmcnt(7)
    v_mfma_f32_32x32x16_bf16 v[80:95], a[136:139], v[140:143], v[80:95]
    ds_read_b64_tr_b16 a[232:233], v36 offset:9216
    ds_read_b64_tr_b16 a[234:235], v36 offset:11264
    ds_read_b64_tr_b16 a[236:237], v37 offset:9216
    ds_read_b64_tr_b16 a[238:239], v37 offset:11264
    v_lshlrev_b32 v114, 16, v71
    v_and_b32 v115, s71, v71
    v_mfma_f32_32x32x16_bf16 v[96:111], a[140:143], v[140:143], v[96:111]
    ds_read_b128 v[136:139], v3 offset:20480
    v_add_f32 v114, v114, v250
    v_add_f32 v115, v115, v250
    v_cvt_pk_bf16_f32 v71, v114, v115
    ds_write_b128 v24, v[68:71] offset:37888
    s_waitcnt lgkmcnt(11)
    v_mfma_f32_32x32x16_bf16 v[80:95], a[144:147], v[144:147], v[80:95]
    s_waitcnt vmcnt(17)
    v_lshlrev_b32 v112, 16, v64
    buffer_load_dwordx4 v34, s[48:51], s99 offen offset:2048  lds
    v_and_b32 v113, s71, v64
    v_add_f32 v112, v112, v250
    v_add_f32 v113, v113, v250
    v_mfma_f32_32x32x16_bf16 v[96:111], a[148:151], v[144:147], v[96:111]
    ds_read_b128 v[140:143], v3 offset:21504
    v_cvt_pk_bf16_f32 v64, v112, v113
    v_lshlrev_b32 v114, 16, v65
    v_and_b32 v115, s71, v65
    v_add_f32 v114, v114, v250
    s_waitcnt lgkmcnt(7)
    v_mfma_f32_32x32x16_bf16 v[80:95], a[152:155], v[148:151], v[80:95]
    v_add_f32 v115, v115, v250
    v_cvt_pk_bf16_f32 v65, v114, v115
    v_lshlrev_b32 v112, 16, v66
    v_and_b32 v113, s71, v66
    v_add_f32 v112, v112, v250
    v_add_f32_e64 v113, v113, v250
    v_mfma_f32_32x32x16_bf16 v[96:111], a[156:159], v[148:151], v[96:111]
    ds_read_b128 v[144:147], v3 offset:22528
    buffer_load_dwordx4 v35, s[48:51], s99 offen offset:3072  lds
    s_add_u32 s99, s13, 65536
    v_cvt_pk_bf16_f32 v66, v112, v113
    v_lshlrev_b32 v114, 16, v67
    s_waitcnt lgkmcnt(3)
    v_mfma_f32_32x32x16_bf16 v[80:95], a[160:163], v[136:139], v[80:95]
    v_and_b32 v115, s71, v67
    v_add_f32 v114, v114, v250
    v_add_f32 v115, v115, v250
    v_cvt_pk_bf16_f32 v67, v114, v115
    ds_write_b128 v24, v[64:67] offset:36864
    s_waitcnt vmcnt(18)
    v_lshlrev_b32 v112, 16, v60
    v_mfma_f32_32x32x16_bf16 v[96:111], a[164:167], v[136:139], v[96:111]
    ds_read_b128 v[148:151], v3 offset:23552
    v_and_b32 v113, s71, v60
    s_add_u32 m0, s98, 8192
    s_nop 0
    buffer_load_dwordx4 v32, s[48:51], s99 offen offset:0  lds
    v_add_f32 v112, v112, v250
    s_waitcnt lgkmcnt(3)
    v_mfma_f32_32x32x16_bf16 v[80:95], a[168:171], v[140:143], v[80:95]
    v_add_f32 v113, v113, v250
    v_cvt_pk_bf16_f32 v60, v112, v113
    v_lshlrev_b32 v114, 16, v61
    v_and_b32 v115, s71, v61
    v_add_f32 v114, v114, v250
    v_add_f32 v115, v115, v250
    v_mfma_f32_32x32x16_bf16 v[96:111], a[172:175], v[140:143], v[96:111]
    ds_read_b128 v[136:139], v3 offset:24576
    v_cvt_pk_bf16_f32 v61, v114, v115
    v_lshlrev_b32 v112, 16, v62
    v_and_b32 v113, s71, v62
    v_add_f32 v112, v112, v250
    s_waitcnt lgkmcnt(3)
    v_mfma_f32_32x32x16_bf16 v[80:95], a[176:179], v[144:147], v[80:95]
    v_add_f32 v113, v113, v250
    v_cvt_pk_bf16_f32 v62, v112, v113
    v_lshlrev_b32 v114, 16, v63
    v_and_b32 v115, s71, v63
    v_add_f32 v114, v114, v250
    v_add_f32 v115, v115, v250
    v_mfma_f32_32x32x16_bf16 v[96:111], a[180:183], v[144:147], v[96:111]
    ds_read_b128 v[140:143], v3 offset:25600
    s_waitcnt vmcnt(9)
    ds_read_b64_tr_b16 a[240:241], v36 offset:12288
    ds_read_b64_tr_b16 a[242:243], v36 offset:14336
    ds_read_b64_tr_b16 a[244:245], v37 offset:12288
    s_waitcnt lgkmcnt(5)
    v_mfma_f32_32x32x16_bf16 v[80:95], a[184:187], v[148:151], v[80:95]
    ds_read_b64_tr_b16 a[246:247], v37 offset:14336
    buffer_load_dwordx4 v33, s[48:51], s99 offen offset:1024  lds
    ds_read_b64_tr_b16 a[248:249], v36 offset:13312
    ds_read_b64_tr_b16 a[250:251], v36 offset:15360
    ds_read_b64_tr_b16 a[252:253], v37 offset:13312
    ds_read_b64_tr_b16 a[254:255], v37 offset:15360
    v_mfma_f32_32x32x16_bf16 v[96:111], a[188:191], v[148:151], v[96:111]
    ds_read_b128 v[144:147], v3 offset:26624
    v_cvt_pk_bf16_f32 v63, v114, v115
    ds_write_b128 v24, v[60:63] offset:35840
    buffer_load_dwordx4 v34, s[48:51], s99 offen offset:2048  lds
    v_lshlrev_b32 v112, 16, v56
    s_waitcnt lgkmcnt(11)
    v_mfma_f32_32x32x16_bf16 v[80:95], a[192:195], v[136:139], v[80:95]
    v_and_b32 v113, s71, v56
    v_add_f32 v112, v112, v250
    v_add_f32 v113, v113, v250
    v_cvt_pk_bf16_f32 v56, v112, v113
    v_lshlrev_b32 v114, 16, v57
    v_and_b32 v115, s71, v57
    v_mfma_f32_32x32x16_bf16 v[96:111], a[196:199], v[136:139], v[96:111]
    ds_read_b128 v[148:151], v3 offset:27648
    v_add_f32 v114, v114, v250
    v_add_f32 v115, v115, v250
    buffer_load_dwordx4 v35, s[48:51], s99 offen offset:3072  lds
    s_add_u32 s99, s13, 98304
    s_waitcnt lgkmcnt(11)
    v_mfma_f32_32x32x16_bf16 v[80:95], a[200:203], v[140:143], v[80:95]
    v_cvt_pk_bf16_f32 v57, v114, v115
    v_lshlrev_b32 v112, 16, v58
    v_and_b32 v113, s71, v58
    v_add_f32 v112, v112, v250
    v_add_f32_e64 v113, v113, v250
    v_cvt_pk_bf16_f32 v58, v112, v113
    v_mfma_f32_32x32x16_bf16 v[96:111], a[204:207], v[140:143], v[96:111]
    ds_read_b128 v[136:139], v3 offset:28672
    v_lshlrev_b32 v114, 16, v59
    v_and_b32 v115, s71, v59
    v_add_f32 v114, v114, v250
    v_add_f32 v115, v115, v250
    s_waitcnt lgkmcnt(3)
    v_mfma_f32_32x32x16_bf16 v[80:95], a[208:211], v[144:147], v[80:95]
    s_add_u32 m0, s98, 12288
    s_nop 0
    buffer_load_dwordx4 v32, s[48:51], s99 offen offset:0  lds
    v_cvt_pk_bf16_f32 v59, v114, v115
    ds_write_b128 v24, v[56:59] offset:34816
    v_lshlrev_b32 v112, 16, v52
    v_and_b32 v113, s71, v52
    v_mfma_f32_32x32x16_bf16 v[96:111], a[212:215], v[144:147], v[96:111]
    ds_read_b128 v[140:143], v3 offset:29696
    v_add_f32 v112, v112, v250
    v_add_f32 v113, v113, v250
    v_cvt_pk_bf16_f32 v52, v112, v113
    v_lshlrev_b32 v114, 16, v53
    s_waitcnt lgkmcnt(3)
    v_mfma_f32_32x32x16_bf16 v[80:95], a[216:219], v[148:151], v[80:95]
    v_and_b32 v115, s71, v53
    v_add_f32 v114, v114, v250
    v_add_f32 v115, v115, v250
    v_cvt_pk_bf16_f32 v53, v114, v115
    v_lshlrev_b32 v112, 16, v54
    v_and_b32 v113, s71, v54
    v_mfma_f32_32x32x16_bf16 v[96:111], a[220:223], v[148:151], v[96:111]
    ds_read_b128 v[144:147], v3 offset:30720
    v_add_f32 v112, v112, v250
    v_add_f32 v113, v113, v250
    v_cvt_pk_bf16_f32 v54, v112, v113
    v_lshlrev_b32 v114, 16, v55
    s_waitcnt lgkmcnt(3)
    v_mfma_f32_32x32x16_bf16 v[80:95], a[224:227], v[136:139], v[80:95]
    s_waitcnt vmcnt(9)
    ds_read_b64_tr_b16 v[160:161], v36 offset:0
    ds_read_b64_tr_b16 v[162:163], v36 offset:1024
    ds_read_b64_tr_b16 v[164:165], v37 offset:0
    ds_read_b64_tr_b16 v[166:167], v37 offset:1024
    buffer_load_dwordx4 v33, s[48:51], s99 offen offset:1024  lds
    v_mfma_f32_32x32x16_bf16 v[96:111], a[228:231], v[136:139], v[96:111]
    ds_read_b128 v[148:151], v3 offset:31744
    ds_read_b64_tr_b16 v[168:169], v36 offset:2048
    ds_read_b64_tr_b16 v[170:171], v36 offset:3072
    ds_read_b64_tr_b16 v[172:173], v37 offset:2048
    ds_read_b64_tr_b16 v[174:175], v37 offset:3072
    s_waitcnt lgkmcnt(10)
    v_mfma_f32_32x32x16_bf16 v[80:95], a[232:235], v[140:143], v[80:95]
    buffer_load_dwordx4 v34, s[48:51], s99 offen offset:2048  lds
    v_and_b32 v115, s71, v55
    v_add_f32 v114, v114, v250
    v_add_f32 v115, v115, v250
    v_cvt_pk_bf16_f32 v55, v114, v115
    ds_write_b128 v24, v[52:55] offset:33792
    v_mfma_f32_32x32x16_bf16 v[96:111], a[236:239], v[140:143], v[96:111]
    v_lshlrev_b32 v112, 16, v48
    v_and_b32 v113, s71, v48
    v_add_f32 v112, v112, v250
    v_add_f32 v113, v113, v250
    v_cvt_pk_bf16_f32 v48, v112, v113
    s_waitcnt lgkmcnt(10)
    v_mfma_f32_32x32x16_bf16 v[80:95], a[240:243], v[144:147], v[80:95]
    buffer_load_dwordx4 v35, s[48:51], s99 offen offset:3072  lds
    s_add_u32 s99, s13, 131072
    v_lshlrev_b32 v114, 16, v49
    v_and_b32 v115, s71, v49
    v_add_f32 v114, v114, v250
    v_add_f32 v115, v115, v250
    v_mfma_f32_32x32x16_bf16 v[96:111], a[244:247], v[144:147], v[96:111]
    v_cvt_pk_bf16_f32 v49, v114, v115
    v_lshlrev_b32 v112, 16, v50
    v_and_b32 v113, s71, v50
    v_add_f32 v112, v112, v250
    v_add_f32 v113, v113, v250
    s_waitcnt lgkmcnt(5)
    v_mfma_f32_32x32x16_bf16 v[80:95], a[248:251], v[148:151], v[80:95]
    v_cvt_pk_bf16_f32 v50, v112, v113
    v_lshlrev_b32 v114, 16, v51
    v_and_b32 v115, s71, v51
    v_add_f32 v114, v114, v250
    s_waitcnt lgkmcnt(1)
    s_add_u32 m0, s98, 0
    s_nop 0
    buffer_load_dwordx4 v32, s[48:51], s99 offen offset:0  lds
    v_mfma_f32_32x32x16_bf16 v[96:111], a[252:255], v[148:151], v[96:111]
    v_add_f32_e64 v115, v115, v250
    v_cvt_pk_bf16_f32 v51, v114, v115
    ds_write_b128 v24, v[48:51] offset:32768
    v_mul_f32 v248, 0x3b000000, v248
    v_mul_f32 v249, 0x3b000000, v249
    v_fma_f32 v249, -v248, v248, v249
    v_max_f32 v249, 0, v249
    v_cvt_pk_bf16_f32 v249, v249, v249
    v_and_b32 v249, s71, v249
    v_add_f32 v249, 0x3727c5ac, v249
    v_cvt_pk_bf16_f32 v249, v249, v249
    v_and_b32 v249, s71, v249
    v_sqrt_f32 v20, v249
    s_nop 0
    v_cvt_pk_bf16_f32 v20, v20, v20
    v_and_b32 v20, s71, v20
    v_rcp_f32 v21, v20
    s_nop 0
    v_mul_f32 v19, 0xc0135761, v21
    v_mul_f32 v18, v21, v21
    v_mul_f32 v18, v18, v21
    v_mul_f32 v18, 0xbdd2d3e8, v18
    s_waitcnt lgkmcnt(0)
    s_barrier
    ds_read_b128 v[136:139], v3 offset:32768
    ds_read_b128 v[140:143], v3 offset:33792
    ds_read_b128 v[144:147], v3 offset:34816
    s_waitcnt lgkmcnt(2)
    v_mfma_f32_32x32x16_bf16 v[48:63], a[0:3], v[136:139], 0
    s_waitcnt vmcnt(9)
    ds_read_b64_tr_b16 v[176:177], v36 offset:4096
    ds_read_b64_tr_b16 v[178:179], v36 offset:5120
    ds_read_b64_tr_b16 v[180:181], v37 offset:4096
    ds_read_b64_tr_b16 v[182:183], v37 offset:5120
    buffer_load_dwordx4 v33, s[48:51], s99 offen offset:1024  lds
    v_mfma_f32_32x32x16_bf16 v[64:79], a[4:7], v[136:139], 0
    ds_read_b128 v[148:151], v3 offset:35840
    ds_read_b64_tr_b16 v[184:185], v36 offset:6144
    ds_read_b64_tr_b16 v[186:187], v36 offset:7168
    ds_read_b64_tr_b16 v[188:189], v37 offset:6144
    ds_read_b64_tr_b16 v[190:191], v37 offset:7168
    s_waitcnt lgkmcnt(10)
    v_mfma_f32_32x32x16_bf16 v[48:63], a[8:11], v[140:143], v[48:63]
    v_lshrrev_b32 v22, 1, v9
    v_lshlrev_b32 v22, 12, v22
    v_and_b32 v25, 1, v0
    v_lshl_add_u32 v22, v25, 8, v22
    buffer_load_dwordx4 v34, s[48:51], s99 offen offset:2048  lds
    v_mul_f32 v112, v80, v80
    v_mfma_f32_32x32x16_bf16 v[64:79], a[12:15], v[140:143], v[64:79]
    ds_read_b128 v[136:139], v3 offset:36864
    v_min_u32_e64 v25, 6, v0
    s_lshl_b32 s64, s3, 5
    v_lshl_add_u32 v25, v25, 2, s64
    buffer_load_dword v26, v22, s[8:11], s25 offen sc1
    buffer_load_dwordx4 v35, s[48:51], s99 offen offset:3072  lds
    s_waitcnt lgkmcnt(10)
    v_mfma_f32_32x32x16_bf16 v[48:63], a[16:19], v[144:147], v[48:63]
    s_add_u32 s99, s13, 163840
    v_mul_f32 v116, v84, v84
    v_mul_f32 v113, v81, v81
    v_mul_f32 v117, v85, v85
    v_mul_f32 v114, v82, v82
    v_mul_f32 v118, v86, v86
    v_mfma_f32_32x32x16_bf16 v[64:79], a[20:23], v[144:147], v[64:79]
    ds_read_b128 v[140:143], v3 offset:37888
    v_mul_f32 v115, v83, v83
    v_mul_f32 v119, v87, v87
    v_fma_f32 v112, v112, v14, v15
    v_fma_f32 v116, v116, v14, v15
    s_waitcnt lgkmcnt(6)
    v_mfma_f32_32x32x16_bf16 v[48:63], a[24:27], v[148:151], v[48:63]
    s_waitcnt lgkmcnt(2)
    s_add_u32 m0, s98, 4096
    s_nop 0
    buffer_load_dwordx4 v32, s[48:51], s99 offen offset:0  lds
    v_fma_f32 v113, v113, v14, v15
    v_fma_f32 v117, v117, v14, v15
    s_waitcnt vmcnt(10)
    ds_read_b64_tr_b16 v[192:193], v36 offset:8192
    v_mfma_f32_32x32x16_bf16 v[64:79], a[28:31], v[148:151], v[64:79]
    ds_read_b128 v[144:147], v3 offset:38912
    ds_read_b64_tr_b16 v[194:195], v36 offset:9216
    ds_read_b64_tr_b16 v[196:197], v37 offset:8192
    ds_read_b64_tr_b16 v[198:199], v37 offset:9216
    v_fma_f32 v114, v114, v14, v15
    s_waitcnt lgkmcnt(6)
    v_mfma_f32_32x32x16_bf16 v[48:63], a[32:35], v[136:139], v[48:63]
    buffer_load_dwordx4 v33, s[48:51], s99 offen offset:1024  lds
    ds_read_b64_tr_b16 v[200:201], v36 offset:10240
    ds_read_b64_tr_b16 v[202:203], v36 offset:11264
    ds_read_b64_tr_b16 v[204:205], v37 offset:10240
    ds_read_b64_tr_b16 v[206:207], v37 offset:11264
    v_fma_f32 v118, v118, v14, v15
    v_mfma_f32_32x32x16_bf16 v[64:79], a[36:39], v[136:139], v[64:79]
    ds_read_b128 v[148:151], v3 offset:39936
    v_fma_f32 v115, v115, v14, v15
    v_fma_f32 v119, v119, v14, v15
    v_mul_f32 v112, v112, v80
    v_mul_f32 v116, v116, v84
    s_waitcnt lgkmcnt(10)
    v_mfma_f32_32x32x16_bf16 v[48:63], a[40:43], v[140:143], v[48:63]
    v_mul_f32 v113, v113, v81
    v_mul_f32 v117, v117, v85
    v_mul_f32 v114, v114, v82
    v_mul_f32 v118, v118, v86
    v_mul_f32 v115, v115, v83
    v_mul_f32 v119, v119, v87
    v_mfma_f32_32x32x16_bf16 v[64:79], a[44:47], v[140:143], v[64:79]
    ds_read_b128 v[136:139], v3 offset:40960
    buffer_load_dwordx4 v34, s[48:51], s99 offen offset:2048  lds
    v_exp_f32 v112, v112
    s_waitcnt lgkmcnt(9)
    v_mfma_f32_32x32x16_bf16 v[48:63], a[48:51], v[144:147], v[48:63]
    v_exp_f32 v116, v116
    v_exp_f32 v113, v113
    v_exp_f32_e64 v117, v117
    v_mfma_f32_32x32x16_bf16 v[64:79], a[52:55], v[144:147], v[64:79]
    ds_read_b128 v[140:143], v3 offset:41984
    buffer_load_dwordx4 v35, s[48:51], s99 offen offset:3072  lds
    s_add_u32 s99, s13, 196608
    v_exp_f32 v114, v114
    s_waitcnt lgkmcnt(2)
    v_mfma_f32_32x32x16_bf16 v[48:63], a[56:59], v[148:151], v[48:63]
    v_exp_f32 v118, v118
    v_exp_f32 v115, v115
    v_exp_f32_e64 v119, v119
    v_mfma_f32_32x32x16_bf16 v[64:79], a[60:63], v[148:151], v[64:79]
    ds_read_b128 v[144:147], v3 offset:43008
    v_fma_f32 v112, v112, v16, v16
    v_fma_f32 v116, v116, v16, v16
    v_fma_f32 v113, v113, v16, v16
    v_fma_f32 v117, v117, v16, v16
    s_waitcnt lgkmcnt(2)
    v_mfma_f32_32x32x16_bf16 v[48:63], a[64:67], v[136:139], v[48:63]
    s_add_u32 m0, s98, 8192
    s_nop 0
    buffer_load_dwordx4 v32, s[48:51], s99 offen offset:0  lds
    v_fma_f32 v114, v114, v16, v16
    v_fma_f32 v118, v118, v16, v16
    v_fma_f32 v115, v115, v16, v16
    v_fma_f32 v119, v119, v16, v16
    v_mfma_f32_32x32x16_bf16 v[64:79], a[68:71], v[136:139], v[64:79]
    ds_read_b128 v[148:151], v3 offset:44032
    s_waitcnt vmcnt(10)
    ds_read_b64_tr_b16 v[208:209], v36 offset:12288
    ds_read_b64_tr_b16 v[210:211], v36 offset:13312
    ds_read_b64_tr_b16 v[212:213], v37 offset:12288
    s_waitcnt lgkmcnt(5)
    v_mfma_f32_32x32x16_bf16 v[48:63], a[72:75], v[140:143], v[48:63]
    ds_read_b64_tr_b16 v[214:215], v37 offset:13312
    v_rcp_f32 v112, v112
    v_rcp_f32 v116, v116
    v_mfma_f32_32x32x16_bf16 v[64:79], a[76:79], v[140:143], v[64:79]
    ds_read_b128 v[136:139], v3 offset:45056
    buffer_load_dwordx4 v33, s[48:51], s99 offen offset:1024  lds
    ds_read_b64_tr_b16 v[216:217], v36 offset:14336
    ds_read_b64_tr_b16 v[218:219], v36 offset:15360
    ds_read_b64_tr_b16 v[220:221], v37 offset:14336
    s_waitcnt lgkmcnt(9)
    v_mfma_f32_32x32x16_bf16 v[48:63], a[80:83], v[144:147], v[48:63]
    ds_read_b64_tr_b16 v[222:223], v37 offset:15360
    v_rcp_f32 v113, v113
    v_rcp_f32_e64 v117, v117
    v_mfma_f32_32x32x16_bf16 v[64:79], a[84:87], v[144:147], v[64:79]
    ds_read_b128 v[140:143], v3 offset:46080
    buffer_load_dwordx4 v34, s[48:51], s99 offen offset:2048  lds
    v_rcp_f32 v114, v114
    s_waitcnt lgkmcnt(10)
    v_mfma_f32_32x32x16_bf16 v[48:63], a[88:91], v[148:151], v[48:63]
    v_rcp_f32 v118, v118
    v_rcp_f32 v115, v115
    v_rcp_f32_e64 v119, v119
    v_mfma_f32_32x32x16_bf16 v[64:79], a[92:95], v[148:151], v[64:79]
    ds_read_b128 v[144:147], v3 offset:47104
    buffer_load_dwordx4 v35, s[48:51], s99 offen offset:3072  lds
    s_add_u32 s99, s13, 229376
    v_mul_f32 v112, v112, v80
    v_mul_f32 v116, v116, v84
    s_waitcnt lgkmcnt(6)
    v_mfma_f32_32x32x16_bf16 v[48:63], a[96:99], v[136:139], v[48:63]
    s_waitcnt vmcnt(9)
    v_cmp_gt_u32 vcc, 4, v26
    s_cbranch_vccnz chk_13_slow
chk_13_ok:
    s_add_u32 s64, s4, 7340032
    s_add_u32 s65, s4, 7371776
    s_lshl_b32 s66, s3, 11
    s_add_u32 m0, s66, 131072
    v_mfma_f32_32x32x16_bf16 v[64:79], a[100:103], v[136:139], v[64:79]
    ds_read_b128 v[148:151], v3 offset:48128
    buffer_load_dwordx4 v27, s[8:11], s64 offen sc1  lds
    buffer_load_dwordx4 v27, s[8:11], s65 offen offset:1024 sc1  lds
    v_mul_f32 v113, v113, v81
    v_mul_f32 v117, v117, v85
    s_waitcnt lgkmcnt(2)
    v_mfma_f32_32x32x16_bf16 v[48:63], a[104:107], v[140:143], v[48:63]
    s_add_u32 m0, s98, 12288
    s_nop 0
    buffer_load_dwordx4 v32, s[48:51], s99 offen offset:0  lds
    v_mfma_f32_32x32x16_bf16 v[64:79], a[108:111], v[140:143], v[64:79]
    ds_read_b128 v[136:139], v3 offset:49152
    s_waitcnt vmcnt(11)
    ds_read_b64_tr_b16 v[224:225], v36 offset:0
    ds_read_b64_tr_b16 v[226:227], v36 offset:1024
    ds_read_b64_tr_b16 v[228:229], v37 offset:0
    s_waitcnt lgkmcnt(5)
    v_mfma_f32_32x32x16_bf16 v[48:63], a[112:115], v[144:147], v[48:63]
    ds_read_b64_tr_b16 v[230:231], v37 offset:1024
    v_mul_f32 v114, v114, v82
    v_mul_f32 v118, v118, v86
    v_mul_f32 v115, v115, v83
    v_mul_f32_e64 v119, v119, v87
    v_cvt_pk_bf16_f32 v152, v112, v113
    v_mfma_f32_32x32x16_bf16 v[64:79], a[116:119], v[144:147], v[64:79]
    ds_read_b128 v[140:143], v3 offset:50176
    buffer_load_dwordx4 v33, s[48:51], s99 offen offset:1024  lds
    ds_read_b64_tr_b16 v[232:233], v36 offset:2048
    ds_read_b64_tr_b16 v[234:235], v36 offset:3072
    ds_read_b64_tr_b16 v[236:237], v37 offset:2048
    s_waitcnt lgkmcnt(9)
    v_mfma_f32_32x32x16_bf16 v[48:63], a[120:123], v[148:151], v[48:63]
    ds_read_b64_tr_b16 v[238:239], v37 offset:3072
    v_cvt_pk_bf16_f32 v154, v116, v117
    v_cvt_pk_bf16_f32 v153, v114, v115
    v_cvt_pk_bf16_f32 v155, v118, v119
    buffer_store_dwordx4 v[152:155], v3, s[8:11], s24 offen offset:0  sc1
    v_mfma_f32_32x32x16_bf16 v[64:79], a[124:127], v[148:151], v[64:79]
    ds_read_b128 v[144:147], v3 offset:51200
    buffer_load_dwordx4 v34, s[48:51], s99 offen offset:2048  lds
    s_waitcnt lgkmcnt(10)
    v_mfma_f32_32x32x16_bf16 v[48:63], a[128:131], v[136:139], v[48:63]
    v_mul_f32 v112, v88, v88
    v_mul_f32 v116, v92, v92
    v_mul_f32 v113, v89, v89
    v_mul_f32 v117, v93, v93
    v_mul_f32 v114, v90, v90
    v_mul_f32 v118, v94, v94
    v_mfma_f32_32x32x16_bf16 v[64:79], a[132:135], v[136:139], v[64:79]
    ds_read_b128 v[148:151], v3 offset:52224
    buffer_load_dwordx4 v35, s[48:51], s99 offen offset:3072  lds
    s_waitcnt lgkmcnt(6)
    v_mfma_f32_32x32x16_bf16 v[48:63], a[136:139], v[140:143], v[48:63]
    s_add_u32 s99, s13, 262144
    v_mul_f32 v115, v91, v91
    v_mul_f32_e64 v119, v95, v95
    v_fma_f32 v112, v112, v14, v15
    v_fma_f32 v116, v116, v14, v15
    v_fma_f32 v113, v113, v14, v15
    v_mfma_f32_32x32x16_bf16 v[64:79], a[140:143], v[140:143], v[64:79]
    ds_read_b128 v[136:139], v3 offset:53248
    v_fma_f32 v117, v117, v14, v15
    v_fma_f32 v114, v114, v14, v15
    v_fma_f32 v118, v118, v14, v15
    v_fma_f32 v115, v115, v14, v15
    s_waitcnt lgkmcnt(2)
    v_mfma_f32_32x32x16_bf16 v[48:63], a[144:147], v[144:147], v[48:63]
    s_add_u32 m0, s98, 0
    s_nop 0
    buffer_load_dwordx4 v32, s[48:51], s99 offen offset:0  lds
    s_waitcnt vmcnt(12)
    ds_read_b64_tr_b16 v[240:241], v36 offset:4096
    ds_read_b64_tr_b16 v[242:243], v36 offset:5120
    ds_read_b64_tr_b16 v[244:245], v37 offset:4096
    v_mfma_f32_32x32x16_bf16 v[64:79], a[148:151], v[144:147], v[64:79]
    ds_read_b128 v[140:143], v3 offset:54272
    ds_read_b64_tr_b16 v[246:247], v37 offset:5120
    v_fma_f32 v119, v119, v14, v15
    v_mul_f32 v112, v112, v88
    v_mul_f32_e64 v116, v116, v92
    s_waitcnt lgkmcnt(6)
    v_mfma_f32_32x32x16_bf16 v[48:63], a[152:155], v[148:151], v[48:63]
    buffer_load_dwordx4 v33, s[48:51], s99 offen offset:1024  lds
    ds_read_b64_tr_b16 v[248:249], v36 offset:6144
    ds_read_b64_tr_b16 v[250:251], v36 offset:7168
    ds_read_b64_tr_b16 v[252:253], v37 offset:6144
    ds_read_b64_tr_b16 v[254:255], v37 offset:7168
    v_mul_f32 v113, v113, v89
    v_mfma_f32_32x32x16_bf16 v[64:79], a[156:159], v[148:151], v[64:79]
    ds_read_b128 v[144:147], v3 offset:55296
    v_mul_f32 v117, v117, v93
    v_mul_f32 v114, v114, v90
    v_mul_f32 v118, v118, v94
    v_mul_f32 v115, v115, v91
    s_waitcnt lgkmcnt(10)
    v_mfma_f32_32x32x16_bf16 v[48:63], a[160:163], v[136:139], v[48:63]
    v_mul_f32 v119, v119, v95
    v_exp_f32 v112, v112
    v_exp_f32_e64 v116, v116
    v_mfma_f32_32x32x16_bf16 v[64:79], a[164:167], v[136:139], v[64:79]
    ds_read_b128 v[148:151], v3 offset:56320
    buffer_load_dwordx4 v34, s[48:51], s99 offen offset:2048  lds
    v_exp_f32 v113, v113
    s_waitcnt lgkmcnt(7)
    v_mfma_f32_32x32x16_bf16 v[48:63], a[168:171], v[140:143], v[48:63]
    v_exp_f32 v117, v117
    v_exp_f32 v114, v114
    v_exp_f32_e64 v118, v118
    v_mfma_f32_32x32x16_bf16 v[64:79], a[172:175], v[140:143], v[64:79]
    ds_read_b128 v[136:139], v3 offset:57344
    buffer_load_dwordx4 v35, s[48:51], s99 offen offset:3072  lds
    s_add_u32 s99, s13, 294912
    v_exp_f32 v115, v115
    s_waitcnt lgkmcnt(2)
    v_mfma_f32_32x32x16_bf16 v[48:63], a[176:179], v[144:147], v[48:63]
    v_exp_f32_e64 v119, v119
    v_fma_f32 v112, v112, v16, v16
    v_fma_f32 v116, v116, v16, v16
    v_fma_f32 v113, v113, v16, v16
    v_fma_f32 v117, v117, v16, v16
    v_mfma_f32_32x32x16_bf16 v[64:79], a[180:183], v[144:147], v[64:79]
    ds_read_b128 v[140:143], v3 offset:58368
    v_fma_f32 v114, v114, v16, v16
    v_fma_f32 v118, v118, v16, v16
    v_fma_f32 v115, v115, v16, v16
    v_fma_f32 v119, v119, v16, v16
    s_waitcnt lgkmcnt(2)
    v_mfma_f32_32x32x16_bf16 v[48:63], a[184:187], v[148:151], v[48:63]
    s_add_u32 m0, s98, 4096
    s_nop 0
    buffer_load_dwordx4 v32, s[48:51], s99 offen offset:0  lds
    v_rcp_f32 v112, v112
    v_rcp_f32 v116, v116
    v_mfma_f32_32x32x16_bf16 v[64:79], a[188:191], v[148:151], v[64:79]
    ds_read_b128 v[144:147], v3 offset:59392
    v_rcp_f32 v113, v113
    v_rcp_f32 v117, v117
    s_waitcnt lgkmcnt(2)
    v_mfma_f32_32x32x16_bf16 v[48:63], a[192:195], v[136:139], v[48:63]
    buffer_load_dwordx4 v33, s[48:51], s99 offen offset:1024  lds
    v_rcp_f32 v114, v114
    v_rcp_f32 v118, v118
    v_mfma_f32_32x32x16_bf16 v[64:79], a[196:199], v[136:139], v[64:79]
    ds_read_b128 v[148:151], v3 offset:60416
    v_rcp_f32 v115, v115
    v_rcp_f32 v119, v119
    s_waitcnt lgkmcnt(2)
    v_mfma_f32_32x32x16_bf16 v[48:63], a[200:203], v[140:143], v[48:63]
    v_mul_f32 v112, v112, v88
    v_mul_f32 v116, v116, v92
    v_mul_f32 v113, v113, v89
    v_mul_f32 v117, v117, v93
    v_mul_f32 v114, v114, v90
    v_mul_f32 v118, v118, v94
    v_mfma_f32_32x32x16_bf16 v[64:79], a[204:207], v[140:143], v[64:79]
    ds_read_b128 v[136:139], v3 offset:61440
    buffer_load_dwordx4 v34, s[48:51], s99 offen offset:2048  lds
    v_mul_f32 v115, v115, v91
    v_mul_f32 v119, v119, v95
    v_cvt_pk_bf16_f32 v156, v112, v113
    s_waitcnt lgkmcnt(2)
    v_mfma_f32_32x32x16_bf16 v[48:63], a[208:211], v[144:147], v[48:63]
    v_cvt_pk_bf16_f32 v158, v116, v117
    v_cvt_pk_bf16_f32 v157, v114, v115
    v_cvt_pk_bf16_f32 v159, v118, v119
    buffer_store_dwordx4 v[156:159], v3, s[8:11], s24 offen offset:1024  sc1
    v_mul_f32 v112, v96, v96
    v_mul_f32_e64 v116, v100, v100
    v_mfma_f32_32x32x16_bf16 v[64:79], a[212:215], v[144:147], v[64:79]
    ds_read_b128 v[140:143], v3 offset:62464
    buffer_load_dwordx4 v35, s[48:51], s99 offen offset:3072  lds
    v_mul_f32 v113, v97, v97
    v_mul_f32 v117, v101, v101
    v_mul_f32 v114, v98, v98
    s_waitcnt lgkmcnt(2)
    v_mfma_f32_32x32x16_bf16 v[48:63], a[216:219], v[148:151], v[48:63]
    v_mul_f32 v118, v102, v102
    v_mul_f32 v115, v99, v99
    v_mul_f32_e64 v119, v103, v103
    v_fma_f32 v112, v112, v14, v15
    v_fma_f32 v116, v116, v14, v15
    v_fma_f32 v113, v113, v14, v15
    v_mfma_f32_32x32x16_bf16 v[64:79], a[220:223], v[148:151], v[64:79]
    ds_read_b128 v[144:147], v3 offset:63488
    v_fma_f32 v117, v117, v14, v15
    v_fma_f32 v114, v114, v14, v15
    v_fma_f32 v118, v118, v14, v15
    v_fma_f32 v115, v115, v14, v15
    s_waitcnt lgkmcnt(2)
    v_mfma_f32_32x32x16_bf16 v[48:63], a[224:227], v[136:139], v[48:63]
    v_fma_f32 v119, v119, v14, v15
    v_mul_f32 v112, v112, v96
    v_mul_f32 v116, v116, v100
    v_mul_f32 v113, v113, v97
    v_mul_f32 v117, v117, v101
    v_mul_f32 v114, v114, v98
    v_mfma_f32_32x32x16_bf16 v[64:79], a[228:231], v[136:139], v[64:79]
    ds_read_b128 v[148:151], v3 offset:64512
    v_mul_f32 v118, v118, v102
    v_mul_f32 v115, v115, v99
    v_mul_f32 v119, v119, v103
    s_waitcnt lgkmcnt(2)
    v_mfma_f32_32x32x16_bf16 v[48:63], a[232:235], v[140:143], v[48:63]
    v_exp_f32 v112, v112
    v_exp_f32 v116, v116
    v_exp_f32 v113, v113
    v_mfma_f32_32x32x16_bf16 v[64:79], a[236:239], v[140:143], v[64:79]
    v_exp_f32 v117, v117
    v_exp_f32 v114, v114
    s_waitcnt lgkmcnt(1)
    v_mfma_f32_32x32x16_bf16 v[48:63], a[240:243], v[144:147], v[48:63]
    v_exp_f32 v118, v118
    v_exp_f32 v115, v115
    v_exp_f32_e64 v119, v119
    v_mfma_f32_32x32x16_bf16 v[64:79], a[244:247], v[144:147], v[64:79]
    v_fma_f32 v112, v112, v16, v16
    v_fma_f32 v116, v116, v16, v16
    v_fma_f32 v113, v113, v16, v16
    v_fma_f32 v117, v117, v16, v16
    v_fma_f32 v114, v114, v16, v16
    s_waitcnt lgkmcnt(0)
    v_mfma_f32_32x32x16_bf16 v[48:63], a[248:251], v[148:151], v[48:63]
    v_fma_f32 v118, v118, v16, v16
    v_fma_f32 v115, v115, v16, v16
    v_fma_f32 v119, v119, v16, v16
    v_rcp_f32 v112, v112
    v_mfma_f32_32x32x16_bf16 v[64:79], a[252:255], v[148:151], v[64:79]
    v_rcp_f32 v116, v116
    v_rcp_f32 v113, v113
    v_rcp_f32 v114, v114
    v_rcp_f32 v117, v117
    v_rcp_f32 v115, v115
    v_rcp_f32 v118, v118
    v_mul_f32 v112, v112, v96
    v_rcp_f32 v119, v119
    v_mul_f32 v113, v113, v97
    v_mul_f32 v116, v116, v100
    v_mul_f32 v114, v114, v98
    v_mul_f32 v117, v117, v101
    v_mul_f32 v115, v115, v99
    v_mul_f32 v118, v118, v102
    v_mul_f32_e64 v119, v119, v103
    v_cvt_pk_bf16_f32 v152, v112, v113
    v_cvt_pk_bf16_f32 v153, v114, v115
    v_cvt_pk_bf16_f32 v154, v116, v117
    v_cvt_pk_bf16_f32 v155, v118, v119
    v_mul_f32 v112, v104, v104
    buffer_store_dwordx4 v[152:155], v3, s[8:11], s24 offen offset:2048  sc1
    v_mul_f32 v113, v105, v105
    v_mul_f32 v116, v108, v108
    v_mul_f32 v114, v106, v106
    v_mul_f32 v117, v109, v109
    v_mul_f32 v115, v107, v107
    v_mul_f32 v118, v110, v110
    v_fma_f32 v112, v112, v14, v15
    v_mul_f32 v119, v111, v111
    v_fma_f32 v113, v113, v14, v15
    v_fma_f32 v116, v116, v14, v15
    v_fma_f32 v114, v114, v14, v15
    v_fma_f32 v117, v117, v14, v15
    v_fma_f32 v115, v115, v14, v15
    v_fma_f32 v118, v118, v14, v15
    v_mul_f32 v112, v112, v104
    v_fma_f32 v119, v119, v14, v15
    v_mul_f32 v113, v113, v105
    v_mul_f32 v116, v116, v108
    v_mul_f32 v114, v114, v106
    v_mul_f32 v117, v117, v109
    v_mul_f32 v115, v115, v107
    v_mul_f32 v118, v118, v110
    v_exp_f32 v112, v112
    v_mul_f32 v119, v119, v111
    v_exp_f32 v113, v113
    v_exp_f32 v116, v116
    v_exp_f32 v114, v114
    v_exp_f32 v117, v117
    v_exp_f32 v115, v115
    v_exp_f32 v118, v118
    v_fma_f32 v112, v112, v16, v16
    v_exp_f32 v119, v119
    v_fma_f32 v113, v113, v16, v16
    v_fma_f32 v116, v116, v16, v16
    v_fma_f32 v114, v114, v16, v16
    v_fma_f32 v117, v117, v16, v16
    v_fma_f32 v115, v115, v16, v16
    v_fma_f32 v118, v118, v16, v16
    v_rcp_f32 v112, v112
    v_fma_f32 v119, v119, v16, v16
    v_rcp_f32 v113, v113
    v_rcp_f32 v116, v116
    v_rcp_f32 v114, v114
    v_rcp_f32 v117, v117
    v_rcp_f32 v115, v115
    v_rcp_f32 v118, v118
    v_mul_f32 v112, v112, v104
    v_rcp_f32 v119, v119
    v_mul_f32 v113, v113, v105
    v_mul_f32 v116, v116, v108
    v_mul_f32 v114, v114, v106
    v_mul_f32 v117, v117, v109
    v_mul_f32 v115, v115, v107
    v_mul_f32 v118, v118, v110
    v_mul_f32 v119, v119, v111
    v_cvt_pk_bf16_f32 v156, v112, v113
    v_cvt_pk_bf16_f32 v157, v114, v115
    v_cvt_pk_bf16_f32 v158, v116, v117
    v_cvt_pk_bf16_f32 v159, v118, v119
    buffer_store_dwordx4 v[156:159], v3, s[8:11], s24 offen offset:3072  sc1
    v_pk_mul_f32 v[112:113], v[48:49], v[48:49]
    s_lshl_b32 s5, s3, 13
    s_sub_u32 s99, s5, s98
    v_add_u32 v28, s99, v36
    v_add_u32 v29, s99, v37
    s_add_u32 s99, s13, 327680
    v_pk_mul_f32 v[114:115], v[50:51], v[50:51]
    v_pk_mul_f32 v[116:117], v[52:53], v[52:53]
    v_pk_mul_f32 v[118:119], v[54:55], v[54:55]
    s_add_u32 m0, s5, 0
    s_nop 0
    buffer_load_dwordx4 v32, s[48:51], s99 offen offset:0  lds
    v_pk_fma_f32 v[112:113], v[112:113], v[18:19], v[18:19] op_sel:[0,0,1] op_sel_hi:[1,0,1]
    v_pk_fma_f32 v[114:115], v[114:115], v[18:19], v[18:19] op_sel:[0,0,1] op_sel_hi:[1,0,1]
    v_pk_fma_f32 v[116:117], v[116:117], v[18:19], v[18:19] op_sel:[0,0,1] op_sel_hi:[1,0,1]
    v_pk_fma_f32 v[118:119], v[118:119], v[18:19], v[18:19] op_sel:[0,0,1] op_sel_hi:[1,0,1]
    v_pk_mul_f32 v[112:113], v[112:113], v[48:49]
    v_pk_mul_f32 v[114:115], v[114:115], v[50:51]
    v_pk_mul_f32 v[116:117], v[116:117], v[52:53]
    v_pk_mul_f32 v[118:119], v[118:119], v[54:55]
    v_exp_f32 v112, v112
    v_exp_f32 v113, v113
    v_exp_f32 v114, v114
    buffer_load_dwordx4 v33, s[48:51], s99 offen offset:1024  lds
    v_exp_f32 v115, v115
    v_exp_f32 v116, v116
    v_exp_f32 v117, v117
    v_exp_f32 v118, v118
    v_exp_f32 v119, v119
    v_pk_fma_f32 v[112:113], v[112:113], v[20:21], v[20:21] op_sel_hi:[1,0,0]
    v_pk_fma_f32 v[114:115], v[114:115], v[20:21], v[20:21] op_sel_hi:[1,0,0]
    v_pk_fma_f32 v[116:117], v[116:117], v[20:21], v[20:21] op_sel_hi:[1,0,0]
    v_pk_fma_f32 v[118:119], v[118:119], v[20:21], v[20:21] op_sel_hi:[1,0,0]
    v_rcp_f32 v112, v112
    buffer_load_dwordx4 v34, s[48:51], s99 offen offset:2048  lds
    v_rcp_f32 v113, v113
    v_rcp_f32 v114, v114
    v_rcp_f32 v115, v115
    v_rcp_f32 v116, v116
    v_rcp_f32 v117, v117
    v_rcp_f32 v118, v118
    v_rcp_f32 v119, v119
    v_pk_mul_f32 v[112:113], v[112:113], v[48:49]
    buffer_load_dwordx4 v35, s[48:51], s99 offen offset:3072  lds
    v_pk_mul_f32 v[114:115], v[114:115], v[50:51]
    s_add_u32 s99, s13, 360448
    v_pk_mul_f32 v[116:117], v[116:117], v[52:53]
    v_pk_mul_f32 v[118:119], v[118:119], v[54:55]
    v_cvt_pk_bf16_f32 v152, v112, v113
    v_cvt_pk_bf16_f32 v153, v114, v115
    v_cvt_pk_bf16_f32 v154, v116, v117
    v_cvt_pk_bf16_f32 v155, v118, v119
    s_add_u32 s24, s24, 114688
    buffer_store_dwordx4 v[152:155], v3, s[8:11], s24 offen offset:0  sc1
    v_pk_mul_f32 v[112:113], v[56:57], v[56:57]
    v_pk_mul_f32 v[114:115], v[58:59], v[58:59]
    v_pk_mul_f32 v[116:117], v[60:61], v[60:61]
    v_pk_mul_f32 v[118:119], v[62:63], v[62:63]
    v_pk_fma_f32 v[112:113], v[112:113], v[18:19], v[18:19] op_sel:[0,0,1] op_sel_hi:[1,0,1]
    v_pk_fma_f32 v[114:115], v[114:115], v[18:19], v[18:19] op_sel:[0,0,1] op_sel_hi:[1,0,1]
    v_pk_fma_f32 v[116:117], v[116:117], v[18:19], v[18:19] op_sel:[0,0,1] op_sel_hi:[1,0,1]
    v_pk_fma_f32 v[118:119], v[118:119], v[18:19], v[18:19] op_sel:[0,0,1] op_sel_hi:[1,0,1]
    v_pk_mul_f32 v[112:113], v[112:113], v[56:57]
    v_pk_mul_f32 v[114:115], v[114:115], v[58:59]
    v_pk_mul_f32 v[116:117], v[116:117], v[60:61]
    v_pk_mul_f32 v[118:119], v[118:119], v[62:63]
    v_exp_f32 v112, v112
    v_exp_f32 v113, v113
    v_exp_f32 v114, v114
    v_exp_f32 v115, v115
    v_exp_f32 v116, v116
    s_add_u32 m0, s5, 4096
    s_nop 0
    buffer_load_dwordx4 v32, s[48:51], s99 offen offset:0  lds
    v_exp_f32 v117, v117
    v_exp_f32 v118, v118
    v_exp_f32_e64 v119, v119
    v_pk_fma_f32 v[112:113], v[112:113], v[20:21], v[20:21] op_sel_hi:[1,0,0]
    v_pk_fma_f32 v[114:115], v[114:115], v[20:21], v[20:21] op_sel_hi:[1,0,0]
    v_pk_fma_f32 v[116:117], v[116:117], v[20:21], v[20:21] op_sel_hi:[1,0,0]
    v_pk_fma_f32 v[118:119], v[118:119], v[20:21], v[20:21] op_sel_hi:[1,0,0]
    v_rcp_f32 v112, v112
    v_rcp_f32 v113, v113
    v_rcp_f32 v114, v114
    buffer_load_dwordx4 v33, s[48:51], s99 offen offset:1024  lds
    v_rcp_f32 v115, v115
    v_rcp_f32 v116, v116
    v_rcp_f32 v117, v117
    v_rcp_f32 v118, v118
    v_rcp_f32 v119, v119
    v_pk_mul_f32 v[112:113], v[112:113], v[56:57]
    v_pk_mul_f32 v[114:115], v[114:115], v[58:59]
    v_pk_mul_f32 v[116:117], v[116:117], v[60:61]
    v_pk_mul_f32 v[118:119], v[118:119], v[62:63]
    buffer_load_dwordx4 v34, s[48:51], s99 offen offset:2048  lds
    v_cvt_pk_bf16_f32 v156, v112, v113
    v_cvt_pk_bf16_f32 v157, v114, v115
    v_cvt_pk_bf16_f32 v158, v116, v117
    v_cvt_pk_bf16_f32 v159, v118, v119
    s_waitcnt vmcnt(8)
    buffer_load_dwordx4 v35, s[48:51], s99 offen offset:3072  lds
    s_mov_b64 exec, 1
    v_mov_b32 v2, 5
    buffer_store_dword v2, off, s[8:11], s85
    buffer_store_dword v2, off, s[8:11], s83 sc1
    s_mov_b64 exec, -1
    buffer_store_dwordx4 v[156:159], v3, s[8:11], s24 offen offset:1024  sc1
    v_pk_mul_f32 v[112:113], v[64:65], v[64:65]
    v_pk_mul_f32 v[114:115], v[66:67], v[66:67]
    v_pk_mul_f32 v[116:117], v[68:69], v[68:69]
    v_pk_mul_f32 v[118:119], v[70:71], v[70:71]
    v_pk_fma_f32 v[112:113], v[112:113], v[18:19], v[18:19] op_sel:[0,0,1] op_sel_hi:[1,0,1]
    v_pk_fma_f32 v[114:115], v[114:115], v[18:19], v[18:19] op_sel:[0,0,1] op_sel_hi:[1,0,1]
    v_pk_fma_f32 v[116:117], v[116:117], v[18:19], v[18:19] op_sel:[0,0,1] op_sel_hi:[1,0,1]
    v_pk_fma_f32 v[118:119], v[118:119], v[18:19], v[18:19] op_sel:[0,0,1] op_sel_hi:[1,0,1]
    v_pk_mul_f32 v[112:113], v[112:113], v[64:65]
    v_pk_mul_f32 v[114:115], v[114:115], v[66:67]
    v_pk_mul_f32 v[116:117], v[116:117], v[68:69]
    v_pk_mul_f32 v[118:119], v[118:119], v[70:71]
    v_exp_f32 v112, v112
    v_exp_f32 v113, v113
    v_exp_f32 v114, v114
    v_exp_f32 v115, v115
    v_exp_f32 v116, v116
    v_exp_f32 v117, v117
    v_exp_f32 v118, v118
    v_exp_f32 v119, v119
    v_pk_fma_f32 v[112:113], v[112:113], v[20:21], v[20:21] op_sel_hi:[1,0,0]
    v_pk_fma_f32 v[114:115], v[114:115], v[20:21], v[20:21] op_sel_hi:[1,0,0]
    v_pk_fma_f32 v[116:117], v[116:117], v[20:21], v[20:21] op_sel_hi:[1,0,0]
    v_pk_fma_f32 v[118:119], v[118:119], v[20:21], v[20:21] op_sel_hi:[1,0,0]
    v_rcp_f32 v112, v112
    v_rcp_f32 v113, v113
    v_rcp_f32 v114, v114
    v_rcp_f32 v115, v115
    v_rcp_f32 v116, v116
    v_rcp_f32 v117, v117
    v_rcp_f32 v118, v118
    v_rcp_f32 v119, v119
    v_pk_mul_f32 v[112:113], v[112:113], v[64:65]
    v_pk_mul_f32 v[114:115], v[114:115], v[66:67]
    v_pk_mul_f32 v[116:117], v[116:117], v[68:69]
    v_pk_mul_f32 v[118:119], v[118:119], v[70:71]
    v_cvt_pk_bf16_f32 v152, v112, v113
    v_cvt_pk_bf16_f32 v153, v114, v115
    v_cvt_pk_bf16_f32 v154, v116, v117
    v_cvt_pk_bf16_f32 v155, v118, v119
    buffer_store_dwordx4 v[152:155], v3, s[8:11], s24 offen offset:2048  sc1
    v_pk_mul_f32 v[112:113], v[72:73], v[72:73]
    v_pk_mul_f32 v[114:115], v[74:75], v[74:75]
    v_pk_mul_f32 v[116:117], v[76:77], v[76:77]
    v_pk_mul_f32 v[118:119], v[78:79], v[78:79]
    v_pk_fma_f32 v[112:113], v[112:113], v[18:19], v[18:19] op_sel:[0,0,1] op_sel_hi:[1,0,1]
    v_pk_fma_f32 v[114:115], v[114:115], v[18:19], v[18:19] op_sel:[0,0,1] op_sel_hi:[1,0,1]
    v_pk_fma_f32 v[116:117], v[116:117], v[18:19], v[18:19] op_sel:[0,0,1] op_sel_hi:[1,0,1]
    v_pk_fma_f32 v[118:119], v[118:119], v[18:19], v[18:19] op_sel:[0,0,1] op_sel_hi:[1,0,1]
    v_pk_mul_f32 v[112:113], v[112:113], v[72:73]
    v_pk_mul_f32 v[114:115], v[114:115], v[74:75]
    v_pk_mul_f32 v[116:117], v[116:117], v[76:77]
    v_pk_mul_f32 v[118:119], v[118:119], v[78:79]
    v_exp_f32 v112, v112
    v_exp_f32 v113, v113
    v_exp_f32 v114, v114
    v_exp_f32 v115, v115
    v_exp_f32 v116, v116
    v_exp_f32 v117, v117
    v_exp_f32 v118, v118
    v_exp_f32 v119, v119
    v_pk_fma_f32 v[112:113], v[112:113], v[20:21], v[20:21] op_sel_hi:[1,0,0]
    v_pk_fma_f32 v[114:115], v[114:115], v[20:21], v[20:21] op_sel_hi:[1,0,0]
    v_pk_fma_f32 v[116:117], v[116:117], v[20:21], v[20:21] op_sel_hi:[1,0,0]
    v_pk_fma_f32 v[118:119], v[118:119], v[20:21], v[20:21] op_sel_hi:[1,0,0]
    v_rcp_f32 v112, v112
    v_rcp_f32 v113, v113
    v_rcp_f32 v114, v114
    v_rcp_f32 v115, v115
    v_rcp_f32 v116, v116
    v_rcp_f32 v117, v117
    v_rcp_f32 v118, v118
    v_rcp_f32 v119, v119
    v_pk_mul_f32 v[112:113], v[112:113], v[72:73]
    v_pk_mul_f32 v[114:115], v[114:115], v[74:75]
    v_pk_mul_f32 v[116:117], v[116:117], v[76:77]
    v_pk_mul_f32 v[118:119], v[118:119], v[78:79]
    v_cvt_pk_bf16_f32 v156, v112, v113
    v_cvt_pk_bf16_f32 v157, v114, v115
    v_cvt_pk_bf16_f32 v158, v116, v117
    v_cvt_pk_bf16_f32 v159, v118, v119
    buffer_store_dwordx4 v[156:159], v3, s[8:11], s24 offen offset:3072  sc1
    s_barrier
    buffer_load_dword v22, v25, s[8:11], s84 offen sc1
    v_lshl_add_u32 v6, v10, 2, v11
    v_lshlrev_b32 v6, 7, v6
    v_lshl_add_u32 v6, v23, 2, v6
    s_lshl_b32 s64, s3, 3
    s_add_u32 s64, s64, 131072
    v_add_u32 v6, s64, v6
    ds_read_b64_tr_b16 v[144:145], v6 offset:0
    ds_read_b64_tr_b16 v[146:147], v6 offset:2048
    ds_read_b64_tr_b16 v[148:149], v6 offset:4096
    ds_read_b64_tr_b16 v[150:151], v6 offset:6144
    s_mul_i32 s64, s3, 28672
    s_add_u32 s64, s64, s23
    v_add_u32 v14, s64, v3
    ds_read_b64_tr_b16 a[0:1], v36 offset:8192
    ds_read_b64_tr_b16 a[2:3], v36 offset:9216
    ds_read_b64_tr_b16 a[4:5], v37 offset:8192
    ds_read_b64_tr_b16 a[6:7], v37 offset:9216
    ds_read_b64_tr_b16 a[8:9], v36 offset:10240
    ds_read_b64_tr_b16 a[10:11], v36 offset:11264
    ds_read_b64_tr_b16 a[12:13], v37 offset:10240
    ds_read_b64_tr_b16 a[14:15], v37 offset:11264
    ds_read_b64_tr_b16 a[16:17], v36 offset:12288
    ds_read_b64_tr_b16 a[18:19], v36 offset:13312
    ds_read_b64_tr_b16 a[20:21], v37 offset:12288
    ds_read_b64_tr_b16 a[22:23], v37 offset:13312
    s_add_u32 s99, s13, 393216
    s_waitcnt lgkmcnt(4)
    s_add_u32 m0, s98, 8192
    s_nop 0
    buffer_load_dwordx4 v32, s[48:51], s99 offen offset:0  lds
    buffer_load_dwordx4 v33, s[48:51], s99 offen offset:1024  lds
    buffer_load_dwordx4 v34, s[48:51], s99 offen offset:2048  lds
    buffer_load_dwordx4 v35, s[48:51], s99 offen offset:3072  lds
    ds_read_b64_tr_b16 a[24:25], v36 offset:14336
    ds_read_b64_tr_b16 a[26:27], v36 offset:15360
    ds_read_b64_tr_b16 a[28:29], v37 offset:14336
    ds_read_b64_tr_b16 a[30:31], v37 offset:15360
    ds_read_b64_tr_b16 a[32:33], v36 offset:0
    ds_read_b64_tr_b16 a[34:35], v36 offset:1024
    ds_read_b64_tr_b16 a[36:37], v37 offset:0
    ds_read_b64_tr_b16 a[38:39], v37 offset:1024
    s_add_u32 s99, s13, 425984
    s_waitcnt lgkmcnt(4)
    s_add_u32 m0, s98, 12288
    s_nop 0
    buffer_load_dwordx4 v32, s[48:51], s99 offen offset:0  lds
    buffer_load_dwordx4 v33, s[48:51], s99 offen offset:1024  lds
    buffer_load_dwordx4 v34, s[48:51], s99 offen offset:2048  lds
    buffer_load_dwordx4 v35, s[48:51], s99 offen offset:3072  lds
    ds_read_b64_tr_b16 a[40:41], v36 offset:2048
    ds_read_b64_tr_b16 a[42:43], v36 offset:3072
    ds_read_b64_tr_b16 a[44:45], v37 offset:2048
    ds_read_b64_tr_b16 a[46:47], v37 offset:3072
    s_waitcnt vmcnt(8)
    s_mov_b64 exec, 1
    v_mov_b32 v2, 6
    buffer_store_dword v2, off, s[8:11], s85
    buffer_store_dword v2, off, s[8:11], s83 sc1
    s_mov_b64 exec, -1
    v_cmp_gt_u32 vcc, 5, v22
    s_cbranch_vccnz chk_16_slow
chk_16_ok:
    s_mov_b32 s6, 0
    buffer_load_dwordx4 a[128:131], v14, s[8:11], s6 offen offset:0 sc1
    v_add_f32 v38, v38, v39
    v_mov_b32 v39, v38
    s_nop 1
    v_permlane32_swap_b32 v38, v39
    v_add_f32 v38, v38, v39
    v_mov_b32 v39, v38
    s_nop 1
    v_permlane16_swap_b32 v38, v39
    v_add_f32 v38, v38, v39
    v_cvt_pk_bf16_f32 v38, v38, v38
    v_and_b32 v38, s71, v38
    v_mul_f32 v38, 0xbfb8aa3b, v38
    v_exp_f32 v38, v38
    s_nop 0
    v_add_f32 v38, 1.0, v38
    v_rcp_f32 v38, v38
    s_nop 0
    buffer_load_dwordx4 a[132:135], v14, s[8:11], s6 offen offset:1024 sc1
    v_cvt_pk_bf16_f32 v38, v38, v38
    v_and_b32 v38, s71, v38
    v_sub_f32 v39, 1.0, v38
    v_cvt_pk_bf16_f32 v39, v39, v39
    v_and_b32 v39, s71, v39
    s_lshl_b32 s64, s3, 6
    s_add_u32 s64, s64, 155648
    v_lshl_add_u32 v7, v9, 2, s64
    ds_write_b32 v7, v39
    v_xor_b32 v6, v10, v9
    v_lshlrev_b32 v6, 4, v6
    v_lshl_add_u32 v6, v9, 8, v6
    s_lshl_b32 s64, s3, 12
    s_add_u32 s64, s64, 139264
    v_add_u32 v6, s64, v6
    buffer_load_dwordx4 a[136:139], v14, s[8:11], s6 offen offset:2048 sc1
    v_lshlrev_b32 v48, 16, v144
    v_and_b32 v49, s71, v144
    v_lshlrev_b32 v52, 16, v120
    v_and_b32 v53, s71, v120
    v_lshlrev_b32 v56, 16, v128
    v_and_b32 v57, s71, v128
    v_lshlrev_b32 v50, 16, v145
    v_and_b32 v51, s71, v145
    v_lshlrev_b32 v54, 16, v121
    v_and_b32 v55, s71, v121
    v_lshlrev_b32 v58, 16, v129
    v_and_b32 v59, s71, v129
    v_pk_mul_f32 v[48:49], v[48:49], v[52:53]
    v_pk_mul_f32 v[56:57], v[56:57], v[38:39] op_sel:[0,1] op_sel_hi:[1,1]
    v_pk_mul_f32 v[50:51], v[50:51], v[54:55]
    buffer_load_dwordx4 a[140:143], v14, s[8:11], s6 offen offset:3072 sc1
    v_pk_mul_f32 v[58:59], v[58:59], v[38:39] op_sel:[0,1] op_sel_hi:[1,1]
    v_pk_fma_f32 v[60:61], v[48:49], v[38:39], v[56:57] op_sel_hi:[1,0,1]
    v_pk_fma_f32 v[62:63], v[50:51], v[38:39], v[58:59] op_sel_hi:[1,0,1]
    v_xor_b32 v7, 0, v6
    ds_write_b128 v7, v[60:63]
    v_lshlrev_b32 v48, 16, v146
    v_and_b32 v49, s71, v146
    v_lshlrev_b32 v52, 16, v122
    v_and_b32 v53, s71, v122
    v_lshlrev_b32 v56, 16, v130
    v_and_b32 v57, s71, v130
    v_lshlrev_b32 v50, 16, v147
    v_and_b32 v51, s71, v147
    v_lshlrev_b32 v54, 16, v123
    v_and_b32 v55, s71, v123
    s_mov_b32 s6, 4096
    buffer_load_dwordx4 a[144:147], v14, s[8:11], s6 offen offset:0 sc1
    v_lshlrev_b32 v58, 16, v131
    v_and_b32_e64 v59, s71, v131
    v_pk_mul_f32 v[48:49], v[48:49], v[52:53]
    v_pk_mul_f32 v[56:57], v[56:57], v[38:39] op_sel:[0,1] op_sel_hi:[1,1]
    v_pk_mul_f32 v[50:51], v[50:51], v[54:55]
    v_pk_mul_f32 v[58:59], v[58:59], v[38:39] op_sel:[0,1] op_sel_hi:[1,1]
    v_pk_fma_f32 v[64:65], v[48:49], v[38:39], v[56:57] op_sel_hi:[1,0,1]
    v_pk_fma_f32 v[66:67], v[50:51], v[38:39], v[58:59] op_sel_hi:[1,0,1]
    v_xor_b32 v7, 64, v6
    ds_write_b128 v7, v[64:67]
    v_lshlrev_b32 v48, 16, v148
    v_and_b32 v49, s71, v148
    v_lshlrev_b32 v52, 16, v124
    v_and_b32 v53, s71, v124
    v_lshlrev_b32 v56, 16, v132
    v_and_b32 v57, s71, v132
    buffer_load_dwordx4 a[148:151], v14, s[8:11], s6 offen offset:1024 sc1
    v_lshlrev_b32 v50, 16, v149
    v_and_b32 v51, s71, v149
    v_lshlrev_b32 v54, 16, v125
    v_and_b32 v55, s71, v125
    v_lshlrev_b32 v58, 16, v133
    v_and_b32_e64 v59, s71, v133
    v_pk_mul_f32 v[48:49], v[48:49], v[52:53]
    v_pk_mul_f32 v[56:57], v[56:57], v[38:39] op_sel:[0,1] op_sel_hi:[1,1]
    v_pk_mul_f32 v[50:51], v[50:51], v[54:55]
    v_pk_mul_f32 v[58:59], v[58:59], v[38:39] op_sel:[0,1] op_sel_hi:[1,1]
    v_pk_fma_f32 v[68:69], v[48:49], v[38:39], v[56:57] op_sel_hi:[1,0,1]
    v_pk_fma_f32 v[70:71], v[50:51], v[38:39], v[58:59] op_sel_hi:[1,0,1]
    v_xor_b32 v7, 128, v6
    ds_write_b128 v7, v[68:71]
    buffer_load_dwordx4 a[152:155], v14, s[8:11], s6 offen offset:2048 sc1
    v_lshlrev_b32 v48, 16, v150
    v_and_b32 v49, s71, v150
    v_lshlrev_b32 v52, 16, v126
    v_and_b32 v53, s71, v126
    v_lshlrev_b32 v56, 16, v134
    v_and_b32 v57, s71, v134
    v_lshlrev_b32 v50, 16, v151
    v_and_b32 v51, s71, v151
    v_lshlrev_b32 v54, 16, v127
    v_and_b32 v55, s71, v127
    v_lshlrev_b32 v58, 16, v135
    v_and_b32 v59, s71, v135
    v_pk_mul_f32 v[48:49], v[48:49], v[52:53]
    v_pk_mul_f32 v[56:57], v[56:57], v[38:39] op_sel:[0,1] op_sel_hi:[1,1]
    v_pk_mul_f32 v[50:51], v[50:51], v[54:55]
    v_pk_mul_f32 v[58:59], v[58:59], v[38:39] op_sel:[0,1] op_sel_hi:[1,1]
    buffer_load_dwordx4 a[156:159], v14, s[8:11], s6 offen offset:3072 sc1
    v_pk_fma_f32 v[72:73], v[48:49], v[38:39], v[56:57] op_sel_hi:[1,0,1]
    v_pk_fma_f32 v[74:75], v[50:51], v[38:39], v[58:59] op_sel_hi:[1,0,1]
    v_xor_b32 v7, 192, v6
    ds_write_b128 v7, v[72:75]
    s_mov_b32 s6, 8192
    buffer_load_dwordx4 a[160:163], v14, s[8:11], s6 offen offset:0 sc1
    s_waitcnt vmcnt(8)
    v_mfma_f32_32x32x16_bf16 v[80:95], v[160:163], a[128:131], 0
    buffer_load_dwordx4 a[164:167], v14, s[8:11], s6 offen offset:1024 sc1
    ds_read_b64_tr_b16 a[48:49], v36 offset:4096
    ds_read_b64_tr_b16 a[50:51], v36 offset:5120
    ds_read_b64_tr_b16 a[52:53], v37 offset:4096
    ds_read_b64_tr_b16 a[54:55], v37 offset:5120
    ds_read_b64_tr_b16 a[56:57], v36 offset:6144
    v_mfma_f32_32x32x16_bf16 v[96:111], v[164:167], a[128:131], 0
    ds_read_b64_tr_b16 a[58:59], v36 offset:7168
    ds_read_b64_tr_b16 a[60:61], v37 offset:6144
    ds_read_b64_tr_b16 a[62:63], v37 offset:7168
    ds_read_b64_tr_b16 a[64:65], v28 offset:0
    ds_read_b64_tr_b16 a[66:67], v28 offset:1024
    s_waitcnt vmcnt(8)
    v_mfma_f32_32x32x16_bf16 v[80:95], v[168:171], a[132:135], v[80:95]
    buffer_load_dwordx4 a[168:171], v14, s[8:11], s6 offen offset:2048 sc1
    ds_read_b64_tr_b16 a[68:69], v29 offset:0
    ds_read_b64_tr_b16 a[70:71], v29 offset:1024
    ds_read_b64_tr_b16 a[72:73], v28 offset:2048
    ds_read_b64_tr_b16 a[74:75], v28 offset:3072
    ds_read_b64_tr_b16 a[76:77], v29 offset:2048
    v_mfma_f32_32x32x16_bf16 v[96:111], v[172:175], a[132:135], v[96:111]
    ds_read_b64_tr_b16 a[78:79], v29 offset:3072
    ds_read_b64_tr_b16 a[80:81], v28 offset:4096
    ds_read_b64_tr_b16 a[82:83], v28 offset:5120
    ds_read_b64_tr_b16 a[84:85], v29 offset:4096
    ds_read_b64_tr_b16 a[86:87], v29 offset:5120
    s_waitcnt vmcnt(8)
    v_mfma_f32_32x32x16_bf16 v[80:95], v[176:179], a[136:139], v[80:95]
    buffer_load_dwordx4 a[172:175], v14, s[8:11], s6 offen offset:3072 sc1
    ds_read_b64_tr_b16 a[88:89], v28 offset:6144
    ds_read_b64_tr_b16 a[90:91], v28 offset:7168
    ds_read_b64_tr_b16 a[92:93], v29 offset:6144
    ds_read_b64_tr_b16 a[94:95], v29 offset:7168
    ds_read_b64_tr_b16 a[96:97], v36 offset:8192
    v_mfma_f32_32x32x16_bf16 v[96:111], v[180:183], a[136:139], v[96:111]
    ds_read_b64_tr_b16 a[98:99], v36 offset:9216
    ds_read_b64_tr_b16 a[100:101], v37 offset:8192
    ds_read_b64_tr_b16 a[102:103], v37 offset:9216
    ds_read_b64_tr_b16 a[104:105], v36 offset:10240
    ds_read_b64_tr_b16 a[106:107], v36 offset:11264
    s_waitcnt vmcnt(8)
    v_mfma_f32_32x32x16_bf16 v[80:95], v[184:187], a[140:143], v[80:95]
    s_mov_b32 s6, 12288
    buffer_load_dwordx4 a[176:179], v14, s[8:11], s6 offen offset:0 sc1
    ds_read_b64_tr_b16 a[108:109], v37 offset:10240
    ds_read_b64_tr_b16 a[110:111], v37 offset:11264
    ds_read_b64_tr_b16 a[112:113], v36 offset:12288
    ds_read_b64_tr_b16 a[114:115], v36 offset:13312
    v_mfma_f32_32x32x16_bf16 v[96:111], v[188:191], a[140:143], v[96:111]
    ds_read_b64_tr_b16 a[116:117], v37 offset:12288
    ds_read_b64_tr_b16 a[118:119], v37 offset:13312
    ds_read_b64_tr_b16 a[120:121], v36 offset:14336
    ds_read_b64_tr_b16 a[122:123], v36 offset:15360
    ds_read_b64_tr_b16 a[124:125], v37 offset:14336
    s_waitcnt vmcnt(8)
    v_mfma_f32_32x32x16_bf16 v[80:95], v[192:195], a[144:147], v[80:95]
    buffer_load_dwordx4 a[180:183], v14, s[8:11], s6 offen offset:1024 sc1
    ds_read_b64_tr_b16 a[126:127], v37 offset:15360
    v_and_b32 v6, 31, v0
    v_lshrrev_b32 v7, 5, v0
    v_xor_b32 v7, v7, v9
    v_lshlrev_b32 v7, 4, v7
    v_mfma_f32_32x32x16_bf16 v[96:111], v[196:199], a[144:147], v[96:111]
    v_lshl_add_u32 v6, v6, 8, v7
    s_lshl_b32 s64, s3, 13
    v_add_u32 v15, s64, v6
    v_lshrrev_b32 v6, 3, v0
    s_lshl_b32 s64, s3, 3
    s_waitcnt vmcnt(8)
    v_mfma_f32_32x32x16_bf16 v[80:95], v[200:203], a[148:151], v[80:95]
    buffer_load_dwordx4 a[184:187], v14, s[8:11], s6 offen offset:2048 sc1
    v_add_u32 v6, s64, v6
    v_lshlrev_b32 v8, 4, v12
    v_lshl_add_u32 v17, v6, 10, v8
    v_lshlrev_b32 v7, 1, v12
    v_and_b32 v8, 15, v6
    v_mfma_f32_32x32x16_bf16 v[96:111], v[204:207], a[148:151], v[96:111]
    v_xor_b32 v7, v7, v8
    v_lshlrev_b32 v7, 4, v7
    v_lshl_add_u32 v16, v6, 8, v7
    v_lshlrev_b32 v18, 2, v6
    v_xor_b32 v152, 0, v15
    s_waitcnt vmcnt(8)
    v_mfma_f32_32x32x16_bf16 v[80:95], v[208:211], a[152:155], v[80:95]
    buffer_load_dwordx4 a[188:191], v14, s[8:11], s6 offen offset:3072 sc1
    v_xor_b32 v153, 32, v15
    v_xor_b32_e64 v154, 64, v15
    v_xor_b32 v155, 96, v15
    v_xor_b32 v156, 128, v15
    v_xor_b32 v157, 160, v15
    v_mfma_f32_32x32x16_bf16 v[96:111], v[212:215], a[152:155], v[96:111]
    v_xor_b32 v158, 192, v15
    v_xor_b32 v159, 224, v15
    s_waitcnt vmcnt(8)
    v_mfma_f32_32x32x16_bf16 v[80:95], v[216:219], a[156:159], v[80:95]
    s_mov_b32 s6, 16384
    buffer_load_dwordx4 a[192:195], v14, s[8:11], s6 offen offset:0 sc1
    v_mfma_f32_32x32x16_bf16 v[96:111], v[220:223], a[156:159], v[96:111]
    s_waitcnt vmcnt(8)
    v_mfma_f32_32x32x16_bf16 v[80:95], v[224:227], a[160:163], v[80:95]
    buffer_load_dwordx4 a[196:199], v14, s[8:11], s6 offen offset:1024 sc1
    v_mfma_f32_32x32x16_bf16 v[96:111], v[228:231], a[160:163], v[96:111]
    s_waitcnt vmcnt(8)
    v_mfma_f32_32x32x16_bf16 v[80:95], v[232:235], a[164:167], v[80:95]
    buffer_load_dwordx4 a[200:203], v14, s[8:11], s6 offen offset:2048 sc1
    v_mfma_f32_32x32x16_bf16 v[96:111], v[236:239], a[164:167], v[96:111]
    s_waitcnt vmcnt(8)
    v_mfma_f32_32x32x16_bf16 v[80:95], v[240:243], a[168:171], v[80:95]
    buffer_load_dword v26, v25, s[8:11], s84 offen sc1
    buffer_load_dwordx4 a[204:207], v14, s[8:11], s6 offen offset:3072 sc1
    v_mfma_f32_32x32x16_bf16 v[96:111], v[244:247], a[168:171], v[96:111]
    s_waitcnt vmcnt(9)
    v_mfma_f32_32x32x16_bf16 v[80:95], v[248:251], a[172:175], v[80:95]
    s_mov_b32 s6, 20480
    buffer_load_dwordx4 a[208:211], v14, s[8:11], s6 offen offset:0 sc1
    v_mfma_f32_32x32x16_bf16 v[96:111], v[252:255], a[172:175], v[96:111]
    s_waitcnt vmcnt(9)
    v_mfma_f32_32x32x16_bf16 v[80:95], a[0:3], a[176:179], v[80:95]
    buffer_load_dwordx4 a[212:215], v14, s[8:11], s6 offen offset:1024 sc1
    v_mfma_f32_32x32x16_bf16 v[96:111], a[4:7], a[176:179], v[96:111]
    s_waitcnt vmcnt(9)
    v_mfma_f32_32x32x16_bf16 v[80:95], a[8:11], a[180:183], v[80:95]
    buffer_load_dwordx4 a[216:219], v14, s[8:11], s6 offen offset:2048 sc1
    v_mfma_f32_32x32x16_bf16 v[96:111], a[12:15], a[180:183], v[96:111]
    s_waitcnt vmcnt(9)
    v_mfma_f32_32x32x16_bf16 v[80:95], a[16:19], a[184:187], v[80:95]
    buffer_load_dwordx4 a[220:223], v14, s[8:11], s6 offen offset:3072 sc1
    v_mfma_f32_32x32x16_bf16 v[96:111], a[20:23], a[184:187], v[96:111]
    s_waitcnt vmcnt(9)
    v_mfma_f32_32x32x16_bf16 v[80:95], a[24:27], a[188:191], v[80:95]
    s_mov_b32 s6, 24576
    buffer_load_dwordx4 a[224:227], v14, s[8:11], s6 offen offset:0 sc1
    v_mfma_f32_32x32x16_bf16 v[96:111], a[28:31], a[188:191], v[96:111]
    s_waitcnt lgkmcnt(15)
    s_waitcnt vmcnt(9)
    v_mfma_f32_32x32x16_bf16 v[80:95], a[32:35], a[192:195], v[80:95]
    buffer_load_dwordx4 a[228:231], v14, s[8:11], s6 offen offset:1024 sc1
    v_mfma_f32_32x32x16_bf16 v[96:111], a[36:39], a[192:195], v[96:111]
    s_waitcnt vmcnt(9)
    v_mfma_f32_32x32x16_bf16 v[80:95], a[40:43], a[196:199], v[80:95]
    buffer_load_dwordx4 a[232:235], v14, s[8:11], s6 offen offset:2048 sc1
    v_mfma_f32_32x32x16_bf16 v[96:111], a[44:47], a[196:199], v[96:111]
    s_waitcnt vmcnt(9)
    v_mfma_f32_32x32x16_bf16 v[80:95], a[48:51], a[200:203], v[80:95]
    buffer_load_dwordx4 a[236:239], v14, s[8:11], s6 offen offset:3072 sc1
    v_mfma_f32_32x32x16_bf16 v[96:111], a[52:55], a[200:203], v[96:111]
    s_waitcnt vmcnt(8)
    v_mfma_f32_32x32x16_bf16 v[80:95], a[56:59], a[204:207], v[80:95]
    v_cmp_gt_u32 vcc, 6, v26
    s_cbranch_vccnz chk_17_slow
chk_17_ok:
    s_mov_b32 s6, 114688
    buffer_load_dwordx4 a[240:243], v14, s[8:11], s6 offen offset:0 sc1
    v_mfma_f32_32x32x16_bf16 v[96:111], a[60:63], a[204:207], v[96:111]
    s_waitcnt vmcnt(8)
    v_mfma_f32_32x32x16_bf16 v[80:95], a[64:67], a[208:211], v[80:95]
    buffer_load_dwordx4 a[244:247], v14, s[8:11], s6 offen offset:1024 sc1
    v_mfma_f32_32x32x16_bf16 v[96:111], a[68:71], a[208:211], v[96:111]
    s_waitcnt vmcnt(8)
    v_mfma_f32_32x32x16_bf16 v[80:95], a[72:75], a[212:215], v[80:95]
    buffer_load_dwordx4 a[248:251], v14, s[8:11], s6 offen offset:2048 sc1
    v_mfma_f32_32x32x16_bf16 v[96:111], a[76:79], a[212:215], v[96:111]
    s_waitcnt vmcnt(8)
    v_mfma_f32_32x32x16_bf16 v[80:95], a[80:83], a[216:219], v[80:95]
    buffer_load_dwordx4 a[252:255], v14, s[8:11], s6 offen offset:3072 sc1
    v_mfma_f32_32x32x16_bf16 v[96:111], a[84:87], a[216:219], v[96:111]
    s_waitcnt vmcnt(8)
    v_mfma_f32_32x32x16_bf16 v[80:95], a[88:91], a[220:223], v[80:95]
    s_mov_b32 s6, 118784
    buffer_load_dwordx4 a[128:131], v14, s[8:11], s6 offen offset:0 sc1
    v_mfma_f32_32x32x16_bf16 v[96:111], a[92:95], a[220:223], v[96:111]
    s_waitcnt lgkmcnt(8)
    s_waitcnt vmcnt(8)
    v_mfma_f32_32x32x16_bf16 v[80:95], a[96:99], a[224:227], v[80:95]
    buffer_load_dwordx4 a[132:135], v14, s[8:11], s6 offen offset:1024 sc1
    v_mfma_f32_32x32x16_bf16 v[96:111], a[100:103], a[224:227], v[96:111]
    s_waitcnt vmcnt(8)
    v_mfma_f32_32x32x16_bf16 v[80:95], a[104:107], a[228:231], v[80:95]
    buffer_load_dwordx4 a[136:139], v14, s[8:11], s6 offen offset:2048 sc1
    v_mfma_f32_32x32x16_bf16 v[96:111], a[108:111], a[228:231], v[96:111]
    s_waitcnt lgkmcnt(0)
    s_waitcnt vmcnt(8)
    v_mfma_f32_32x32x16_bf16 v[80:95], a[112:115], a[232:235], v[80:95]
    buffer_load_dwordx4 a[140:143], v14, s[8:11], s6 offen offset:3072 sc1
    v_mfma_f32_32x32x16_bf16 v[96:111], a[116:119], a[232:235], v[96:111]
    s_waitcnt vmcnt(8)
    v_mfma_f32_32x32x16_bf16 v[80:95], a[120:123], a[236:239], v[80:95]
    s_mov_b32 s6, 122880
    buffer_load_dwordx4 a[144:147], v14, s[8:11], s6 offen offset:0 sc1
    v_mfma_f32_32x32x16_bf16 v[96:111], a[124:127], a[236:239], v[96:111]
    s_waitcnt vmcnt(8)
    v_mfma_f32_32x32x16_bf16 v[48:63], v[160:163], a[240:243], 0
    buffer_load_dwordx4 a[148:151], v14, s[8:11], s6 offen offset:1024 sc1
    v_mfma_f32_32x32x16_bf16 v[64:79], v[164:167], a[240:243], 0
    s_nop 4
    ds_write_b128 v152, v[80:83] offset:0
    s_waitcnt vmcnt(8)
    v_mfma_f32_32x32x16_bf16 v[48:63], v[168:171], a[244:247], v[48:63]
    buffer_load_dwordx4 a[152:155], v14, s[8:11], s6 offen offset:2048 sc1
    v_mfma_f32_32x32x16_bf16 v[64:79], v[172:175], a[244:247], v[64:79]
    ds_write_b128 v153, v[84:87] offset:0
    s_waitcnt vmcnt(8)
    v_mfma_f32_32x32x16_bf16 v[48:63], v[176:179], a[248:251], v[48:63]
    buffer_load_dwordx4 a[156:159], v14, s[8:11], s6 offen offset:3072 sc1
    v_mfma_f32_32x32x16_bf16 v[64:79], v[180:183], a[248:251], v[64:79]
    ds_write_b128 v154, v[88:91] offset:0
    s_waitcnt vmcnt(8)
    v_mfma_f32_32x32x16_bf16 v[48:63], v[184:187], a[252:255], v[48:63]
    s_mov_b32 s6, 126976
    buffer_load_dwordx4 a[160:163], v14, s[8:11], s6 offen offset:0 sc1
    v_mfma_f32_32x32x16_bf16 v[64:79], v[188:191], a[252:255], v[64:79]
    ds_write_b128 v155, v[92:95] offset:0
    s_waitcnt vmcnt(8)
    v_mfma_f32_32x32x16_bf16 v[48:63], v[192:195], a[128:131], v[48:63]
    buffer_load_dwordx4 a[164:167], v14, s[8:11], s6 offen offset:1024 sc1
    v_mfma_f32_32x32x16_bf16 v[64:79], v[196:199], a[128:131], v[64:79]
    ds_write_b128 v156, v[96:99] offset:0
    s_waitcnt vmcnt(8)
    v_mfma_f32_32x32x16_bf16 v[48:63], v[200:203], a[132:135], v[48:63]
    buffer_load_dwordx4 a[168:171], v14, s[8:11], s6 offen offset:2048 sc1
    v_mfma_f32_32x32x16_bf16 v[64:79], v[204:207], a[132:135], v[64:79]
    ds_write_b128 v157, v[100:103] offset:0
    s_waitcnt vmcnt(8)
    v_mfma_f32_32x32x16_bf16 v[48:63], v[208:211], a[136:139], v[48:63]
    buffer_load_dwordx4 a[172:175], v14, s[8:11], s6 offen offset:3072 sc1
    v_mfma_f32_32x32x16_bf16 v[64:79], v[212:215], a[136:139], v[64:79]
    ds_write_b128 v158, v[104:107] offset:0
    s_waitcnt vmcnt(8)
    v_mfma_f32_32x32x16_bf16 v[48:63], v[216:219], a[140:143], v[48:63]
    s_mov_b32 s6, 131072
    buffer_load_dwordx4 a[176:179], v14, s[8:11], s6 offen offset:0 sc1
    v_mfma_f32_32x32x16_bf16 v[64:79], v[220:223], a[140:143], v[64:79]
    ds_write_b128 v159, v[108:111] offset:0
    s_waitcnt vmcnt(8)
    v_mfma_f32_32x32x16_bf16 v[48:63], v[224:227], a[144:147], v[48:63]
    buffer_load_dwordx4 a[180:183], v14, s[8:11], s6 offen offset:1024 sc1
    v_mfma_f32_32x32x16_bf16 v[64:79], v[228:231], a[144:147], v[64:79]
    s_waitcnt vmcnt(8)
    v_mfma_f32_32x32x16_bf16 v[48:63], v[232:235], a[148:151], v[48:63]
    buffer_load_dwordx4 a[184:187], v14, s[8:11], s6 offen offset:2048 sc1
    v_mfma_f32_32x32x16_bf16 v[64:79], v[236:239], a[148:151], v[64:79]
    s_waitcnt vmcnt(8)
    v_mfma_f32_32x32x16_bf16 v[48:63], v[240:243], a[152:155], v[48:63]
    buffer_load_dwordx4 a[188:191], v14, s[8:11], s6 offen offset:3072 sc1
    v_mfma_f32_32x32x16_bf16 v[64:79], v[244:247], a[152:155], v[64:79]
    s_waitcnt vmcnt(8)
    v_mfma_f32_32x32x16_bf16 v[48:63], v[248:251], a[156:159], v[48:63]
    s_mov_b32 s6, 135168
    buffer_load_dwordx4 a[192:195], v14, s[8:11], s6 offen offset:0 sc1
    v_mfma_f32_32x32x16_bf16 v[64:79], v[252:255], a[156:159], v[64:79]
    s_waitcnt vmcnt(8)
    v_mfma_f32_32x32x16_bf16 v[48:63], a[0:3], a[160:163], v[48:63]
    buffer_load_dwordx4 a[196:199], v14, s[8:11], s6 offen offset:1024 sc1
    v_mfma_f32_32x32x16_bf16 v[64:79], a[4:7], a[160:163], v[64:79]
    s_waitcnt vmcnt(8)
    v_mfma_f32_32x32x16_bf16 v[48:63], a[8:11], a[164:167], v[48:63]
    buffer_load_dwordx4 a[200:203], v14, s[8:11], s6 offen offset:2048 sc1
    v_mfma_f32_32x32x16_bf16 v[64:79], a[12:15], a[164:167], v[64:79]
    s_waitcnt vmcnt(8)
    v_mfma_f32_32x32x16_bf16 v[48:63], a[16:19], a[168:171], v[48:63]
    buffer_load_dwordx4 a[204:207], v14, s[8:11], s6 offen offset:3072 sc1
    v_mfma_f32_32x32x16_bf16 v[64:79], a[20:23], a[168:171], v[64:79]
    s_waitcnt vmcnt(8)
    v_mfma_f32_32x32x16_bf16 v[48:63], a[24:27], a[172:175], v[48:63]
    s_mov_b32 s6, 139264
    buffer_load_dwordx4 a[208:211], v14, s[8:11], s6 offen offset:0 sc1
    v_mfma_f32_32x32x16_bf16 v[64:79], a[28:31], a[172:175], v[64:79]
    s_waitcnt vmcnt(8)
    v_mfma_f32_32x32x16_bf16 v[48:63], a[32:35], a[176:179], v[48:63]
    buffer_load_dwordx4 a[212:215], v14, s[8:11], s6 offen offset:1024 sc1
    v_mfma_f32_32x32x16_bf16 v[64:79], a[36:39], a[176:179], v[64:79]
    s_waitcnt vmcnt(8)
    v_mfma_f32_32x32x16_bf16 v[48:63], a[40:43], a[180:183], v[48:63]
    buffer_load_dwordx4 a[216:219], v14, s[8:11], s6 offen offset:2048 sc1
    v_mfma_f32_32x32x16_bf16 v[64:79], a[44:47], a[180:183], v[64:79]
    s_waitcnt vmcnt(8)
    v_mfma_f32_32x32x16_bf16 v[48:63], a[48:51], a[184:187], v[48:63]
    buffer_load_dwordx4 a[220:223], v14, s[8:11], s6 offen offset:3072 sc1
    s_waitcnt lgkmcnt(0)
    s_barrier
    v_xor_b32_e64 v6, 16, v16
    ds_read_b128 v[80:83], v16 offset:0
    ds_read_b128 v[84:87], v16 offset:8192
    v_mfma_f32_32x32x16_bf16 v[64:79], a[52:55], a[184:187], v[64:79]
    ds_read_b128 v[88:91], v16 offset:16384
    ds_read_b128 v[92:95], v16 offset:24576
    ds_read_b128 v[96:99], v6 offset:0
    ds_read_b128 v[100:103], v6 offset:8192
    ds_read_b128 v[104:107], v6 offset:16384
    s_waitcnt vmcnt(8)
    v_mfma_f32_32x32x16_bf16 v[48:63], a[56:59], a[188:191], v[48:63]
    ds_read_b128 v[108:111], v6 offset:24576
    v_add_u32 v7, 139264, v16
    v_add_u32 v8, 139264, v6
    ds_read_b128 v[112:115], v7
    ds_read_b128 v[116:119], v8
    v_add_u32 v7, 155648, v18
    ds_read_b32 v136, v7
    v_mfma_f32_32x32x16_bf16 v[64:79], a[60:63], a[188:191], v[64:79]
    s_waitcnt lgkmcnt(7)
    v_add_f32 v80, v80, v84
    s_waitcnt vmcnt(7)
    v_mfma_f32_32x32x16_bf16 v[48:63], a[64:67], a[192:195], v[48:63]
    v_add_f32 v81, v81, v85
    v_add_f32 v82, v82, v86
    v_add_f32 v83, v83, v87
    v_add_f32 v88, v88, v92
    v_add_f32 v89, v89, v93
    v_add_f32 v90, v90, v94
    v_mfma_f32_32x32x16_bf16 v[64:79], a[68:71], a[192:195], v[64:79]
    v_add_f32 v91, v91, v95
    v_add_f32 v80, v80, v88
    v_add_f32 v81, v81, v89
    v_add_f32 v82, v82, v90
    v_add_f32 v83, v83, v91
    s_waitcnt vmcnt(6)
    v_mfma_f32_32x32x16_bf16 v[48:63], a[72:75], a[196:199], v[48:63]
    s_waitcnt lgkmcnt(3)
    v_add_f32 v96, v96, v100
    v_add_f32 v97, v97, v101
    v_add_f32 v98, v98, v102
    v_add_f32 v99, v99, v103
    v_add_f32 v104, v104, v108
    v_mfma_f32_32x32x16_bf16 v[64:79], a[76:79], a[196:199], v[64:79]
    v_add_f32 v105, v105, v109
    v_add_f32 v106, v106, v110
    v_add_f32 v107, v107, v111
    v_add_f32 v96, v96, v104
    v_add_f32 v97, v97, v105
    s_waitcnt vmcnt(5)
    v_mfma_f32_32x32x16_bf16 v[48:63], a[80:83], a[200:203], v[48:63]
    v_add_f32 v98, v98, v106
    v_add_f32_e64 v99, v99, v107
    s_waitcnt lgkmcnt(0)
    v_fma_f32 v80, v80, v136, v112
    v_fma_f32 v81, v81, v136, v113
    v_fma_f32 v82, v82, v136, v114
    v_mfma_f32_32x32x16_bf16 v[64:79], a[84:87], a[200:203], v[64:79]
    v_fma_f32 v83, v83, v136, v115
    v_fma_f32 v96, v96, v136, v116
    v_fma_f32 v97, v97, v136, v117
    v_fma_f32 v98, v98, v136, v118
    v_fma_f32 v99, v99, v136, v119
    s_waitcnt vmcnt(4)
    v_mfma_f32_32x32x16_bf16 v[48:63], a[88:91], a[204:207], v[48:63]
    v_cvt_pk_bf16_f32 v84, v80, v81
    v_cvt_pk_bf16_f32 v85, v82, v83
    v_cvt_pk_bf16_f32 v86, v96, v97
    v_cvt_pk_bf16_f32 v87, v98, v99
    s_add_u32 s64, s75, 0
    buffer_store_dwordx4 v[84:87], v17, s[56:59], s64 offen sc1
    v_mfma_f32_32x32x16_bf16 v[64:79], a[92:95], a[204:207], v[64:79]
    s_waitcnt vmcnt(4)
    v_mfma_f32_32x32x16_bf16 v[48:63], a[96:99], a[208:211], v[48:63]
    v_mfma_f32_32x32x16_bf16 v[64:79], a[100:103], a[208:211], v[64:79]
    s_waitcnt vmcnt(3)
    v_mfma_f32_32x32x16_bf16 v[48:63], a[104:107], a[212:215], v[48:63]
    v_mfma_f32_32x32x16_bf16 v[64:79], a[108:111], a[212:215], v[64:79]
    v_xor_b32_e64 v6, 16, v16
    v_add_u32 v7, 147456, v16
    v_add_u32 v8, 147456, v6
    ds_read_b128 v[112:115], v7
    ds_read_b128 v[116:119], v8
    v_add_u32 v7, 155776, v18
    ds_read_b32 v136, v7
    s_add_u32 s64, s75, 32768
    s_waitcnt vmcnt(1)
    v_mfma_f32_32x32x16_bf16 v[48:63], a[112:115], a[216:219], v[48:63]
    v_mfma_f32_32x32x16_bf16 v[48:63], a[120:123], a[220:223], v[48:63]
    v_mfma_f32_32x32x16_bf16 v[64:79], a[116:119], a[216:219], v[64:79]
    v_mfma_f32_32x32x16_bf16 v[64:79], a[124:127], a[220:223], v[64:79]
    s_nop 9
    ds_write_b128 v152, v[48:51] offset:32768
    ds_write_b128 v153, v[52:55] offset:32768
    ds_write_b128 v154, v[56:59] offset:32768
    ds_write_b128 v155, v[60:63] offset:32768
    ds_write_b128 v156, v[64:67] offset:32768
    ds_write_b128 v157, v[68:71] offset:32768
    ds_write_b128 v158, v[72:75] offset:32768
    ds_write_b128 v159, v[76:79] offset:32768
    s_waitcnt lgkmcnt(0)
    s_barrier
    ds_read_b128 v[80:83], v16 offset:32768
    ds_read_b128 v[84:87], v16 offset:40960
    ds_read_b128 v[88:91], v16 offset:49152
    ds_read_b128 v[92:95], v16 offset:57344
    ds_read_b128 v[96:99], v6 offset:32768
    ds_read_b128 v[100:103], v6 offset:40960
    ds_read_b128 v[104:107], v6 offset:49152
    ds_read_b128 v[108:111], v6 offset:57344
    s_waitcnt lgkmcnt(4)
    v_pk_add_f32 v[80:81], v[80:81], v[84:85]
    v_pk_add_f32 v[82:83], v[82:83], v[86:87]
    v_pk_add_f32 v[88:89], v[88:89], v[92:93]
    v_pk_add_f32 v[90:91], v[90:91], v[94:95]
    v_pk_add_f32 v[80:81], v[80:81], v[88:89]
    v_pk_add_f32 v[82:83], v[82:83], v[90:91]
    s_waitcnt lgkmcnt(0)
    v_pk_add_f32 v[96:97], v[96:97], v[100:101]
    v_pk_add_f32 v[98:99], v[98:99], v[102:103]
    v_pk_add_f32 v[104:105], v[104:105], v[108:109]
    v_pk_add_f32 v[106:107], v[106:107], v[110:111]
    v_pk_add_f32 v[96:97], v[96:97], v[104:105]
    v_pk_add_f32 v[98:99], v[98:99], v[106:107]
    v_pk_fma_f32 v[80:81], v[80:81], v[136:137], v[112:113] op_sel_hi:[1,0,1]
    v_pk_fma_f32 v[82:83], v[82:83], v[136:137], v[114:115] op_sel_hi:[1,0,1]
    v_pk_fma_f32 v[96:97], v[96:97], v[136:137], v[116:117] op_sel_hi:[1,0,1]
    v_pk_fma_f32 v[98:99], v[98:99], v[136:137], v[118:119] op_sel_hi:[1,0,1]
    v_cvt_pk_bf16_f32 v84, v80, v81
    v_cvt_pk_bf16_f32 v85, v82, v83
    v_cvt_pk_bf16_f32 v86, v96, v97
    v_cvt_pk_bf16_f32 v87, v98, v99
    buffer_store_dwordx4 v[84:87], v17, s[56:59], s64 offen sc1
    s_endpgm
chk_2_slow:
    s_sub_u32 s72, s72, 1
    s_cbranch_scc1 chk_2_out
    buffer_load_dword v17, v13, s[20:23], 0 offen sc1
    s_waitcnt vmcnt(0)
    v_cmp_gt_u32 vcc, 1, v17
    s_cbranch_vccnz chk_2_slow
    s_branch chk_2_ok
chk_2_out:
    s_mov_b32 s72, 0
    s_branch chk_2_ok
chk_4_slow:
    s_sub_u32 s72, s72, 1
    s_cbranch_scc1 chk_4_out
    buffer_load_dword v15, v14, s[8:11], s84 offen sc1
    s_waitcnt vmcnt(0)
    v_cmp_gt_u32 vcc, 1, v15
    s_cbranch_vccz chk_4_ok
    buffer_load_dword v15, v14, s[8:11], s84 offen sc1
    s_waitcnt vmcnt(0)
    v_cmp_gt_u32 vcc, 1, v15
    s_cbranch_vccz chk_4_ok
    buffer_load_dword v15, v14, s[8:11], s84 offen sc1
    s_waitcnt vmcnt(0)
    v_cmp_gt_u32 vcc, 1, v15
    s_cbranch_vccz chk_4_ok
    v_lshlrev_b32 v15, 5, v14
    buffer_load_dword v15, v15, s[8:11], s82 offen sc1
    s_waitcnt vmcnt(0)
    v_cmp_gt_u32 vcc, 1, v15
    s_cbranch_vccnz chk_4_slow
    s_branch chk_4_ok
chk_4_out:
    s_mov_b32 s72, 0
    s_branch chk_4_ok
chk_6_slow:
    s_sub_u32 s72, s72, 1
    s_cbranch_scc1 chk_6_out
    buffer_load_dword v29, v28, s[8:11], s12 offen sc1
    s_waitcnt vmcnt(0)
    v_cmp_gt_u32 vcc, 2, v29
    s_cbranch_vccnz chk_6_slow
    s_branch chk_6_ok
chk_6_out:
    s_mov_b32 s72, 0
    s_branch chk_6_ok
chk_10_slow:
    s_sub_u32 s72, s72, 1
    s_cbranch_scc1 chk_10_out
    buffer_load_dword v24, v13, s[8:11], s84 offen sc1
    s_waitcnt vmcnt(0)
    v_cmp_gt_u32 vcc, 3, v24
    s_cbranch_vccz chk_10_ok
    buffer_load_dword v24, v13, s[8:11], s84 offen sc1
    s_waitcnt vmcnt(0)
    v_cmp_gt_u32 vcc, 3, v24
    s_cbranch_vccz chk_10_ok
    buffer_load_dword v24, v13, s[8:11], s84 offen sc1
    s_waitcnt vmcnt(0)
    v_cmp_gt_u32 vcc, 3, v24
    s_cbranch_vccz chk_10_ok
    v_lshlrev_b32 v24, 5, v13
    buffer_load_dword v24, v24, s[8:11], s82 offen sc1
    s_waitcnt vmcnt(0)
    v_cmp_gt_u32 vcc, 3, v24
    s_cbranch_vccnz chk_10_slow
    s_branch chk_10_ok
chk_10_out:
    s_mov_b32 s72, 0
    s_branch chk_10_ok
chk_11_slow:
    s_sub_u32 s72, s72, 1
    s_cbranch_scc1 chk_11_out
    buffer_load_dword v24, v13, s[8:11], s84 offen sc1
    s_waitcnt vmcnt(0)
    v_cmp_gt_u32 vcc, 3, v24
    s_cbranch_vccz chk_11_ok
    buffer_load_dword v24, v13, s[8:11], s84 offen sc1
    s_waitcnt vmcnt(0)
    v_cmp_gt_u32 vcc, 3, v24
    s_cbranch_vccz chk_11_ok
    buffer_load_dword v24, v13, s[8:11], s84 offen sc1
    s_waitcnt vmcnt(0)
    v_cmp_gt_u32 vcc, 3, v24
    s_cbranch_vccz chk_11_ok
    v_lshlrev_b32 v24, 5, v13
    buffer_load_dword v24, v24, s[8:11], s82 offen sc1
    s_waitcnt vmcnt(0)
    v_cmp_gt_u32 vcc, 3, v24
    s_cbranch_vccnz chk_11_slow
    s_branch chk_11_ok
chk_11_out:
    s_mov_b32 s72, 0
    s_branch chk_11_ok
chk_13_slow:
    s_sub_u32 s72, s72, 1
    s_cbranch_scc1 chk_13_out
    buffer_load_dword v26, v22, s[8:11], s25 offen sc1
    s_waitcnt vmcnt(0)
    v_cmp_gt_u32 vcc, 4, v26
    s_cbranch_vccnz chk_13_slow
    s_branch chk_13_ok
chk_13_out:
    s_mov_b32 s72, 0
    s_branch chk_13_ok
chk_16_slow:
    s_sub_u32 s72, s72, 1
    s_cbranch_scc1 chk_16_out
    buffer_load_dword v22, v25, s[8:11], s84 offen sc1
    s_waitcnt vmcnt(0)
    v_cmp_gt_u32 vcc, 5, v22
    s_cbranch_vccz chk_16_ok
    buffer_load_dword v22, v25, s[8:11], s84 offen sc1
    s_waitcnt vmcnt(0)
    v_cmp_gt_u32 vcc, 5, v22
    s_cbranch_vccz chk_16_ok
    buffer_load_dword v22, v25, s[8:11], s84 offen sc1
    s_waitcnt vmcnt(0)
    v_cmp_gt_u32 vcc, 5, v22
    s_cbranch_vccz chk_16_ok
    v_lshlrev_b32 v22, 5, v25
    buffer_load_dword v22, v22, s[8:11], s82 offen sc1
    s_waitcnt vmcnt(0)
    v_cmp_gt_u32 vcc, 5, v22
    s_cbranch_vccnz chk_16_slow
    s_branch chk_16_ok
chk_16_out:
    s_mov_b32 s72, 0
    s_branch chk_16_ok
chk_17_slow:
    s_sub_u32 s72, s72, 1
    s_cbranch_scc1 chk_17_out
    buffer_load_dword v26, v25, s[8:11], s84 offen sc1
    s_waitcnt vmcnt(0)
    v_cmp_gt_u32 vcc, 6, v26
    s_cbranch_vccz chk_17_ok
    buffer_load_dword v26, v25, s[8:11], s84 offen sc1
    s_waitcnt vmcnt(0)
    v_cmp_gt_u32 vcc, 6, v26
    s_cbranch_vccz chk_17_ok
    buffer_load_dword v26, v25, s[8:11], s84 offen sc1
    s_waitcnt vmcnt(0)
    v_cmp_gt_u32 vcc, 6, v26
    s_cbranch_vccz chk_17_ok
    v_lshlrev_b32 v26, 5, v25
    buffer_load_dword v26, v26, s[8:11], s82 offen sc1
    s_waitcnt vmcnt(0)
    v_cmp_gt_u32 vcc, 6, v26
    s_cbranch_vccnz chk_17_slow
    s_branch chk_17_ok
chk_17_out:
    s_mov_b32 s72, 0
    s_branch chk_17_ok
L_end:
    s_endpgm

.section .rodata,"a"
.p2align 6
.amdhsa_kernel gated_mix__ssm_conv_h3__mixer_s_mlp__prompt_kernel
  .amdhsa_next_free_vgpr 512
  .amdhsa_next_free_sgpr 102
  .amdhsa_accum_offset 256
  .amdhsa_group_segment_fixed_size 0
  .amdhsa_kernarg_size 120
  .amdhsa_user_sgpr_count 2
  .amdhsa_user_sgpr_kernarg_segment_ptr 1
  .amdhsa_system_sgpr_workgroup_id_x 1
  .amdhsa_float_denorm_mode_32 3
.end_amdhsa_kernel
```
